```python
import torch

def _softmax(x, axis=-1):
    return torch.softmax(x, dim=axis)
def _gelu(x):
    return torch.nn.functional.gelu(x, approximate="tanh")
def _silu(x):
    return torch.nn.functional.silu(x)
def _sigmoid(x):
    return torch.sigmoid(x)
def _layernorm(x, axis=-1, eps=1e-5):
    m = x.mean(dim=axis, keepdim=True)
    v = x.var(dim=axis, keepdim=True, unbiased=False)
    return (x - m) / torch.sqrt(v + eps)
def _scatter_add(tgt, idx, src, axis=0):
    return tgt.clone().index_add_(axis, idx, src)
def _segment_sum(src, seg, n):
    out = torch.zeros((n,) + src.shape[1:], dtype=src.dtype)
    return out.index_add_(0, seg, src)
def _pad(x, pw):
    flat = tuple(v for pair in reversed(pw) for v in pair)
    return torch.nn.functional.pad(x, flat)

kernel_name = 'standalone__gqa_block_cached__near_ridge'

def setup_inputs():

    _w = (lambda a: (lambda t: t.to(torch.bfloat16) if t.is_floating_point() else t)(torch.as_tensor(a)))
    B, Sq, D = 16, 48, 448
    Hq, Hkv, Sk, Dh = 16, 8, 48, 256
    assert Hq % Hkv == 0, (Hq, Hkv)
    return {
        "x": _w((lambda *s: torch.randn(*s, dtype=torch.bfloat16) * 0.8)(B, Sq, D)),
        "k_cache": _w((lambda *s: torch.randn(*s, dtype=torch.bfloat16) * 0.8)(B, Hkv, Sk, Dh)),
        "v_cache": _w((lambda *s: torch.randn(*s, dtype=torch.bfloat16) * 0.05)(B, Hkv, Sk, Dh)),
        "wq": _w((lambda *s: torch.randn(*s, dtype=torch.bfloat16) * 0.8)(D, Hq * Dh) * (D ** -0.5)),
        "wo": _w((lambda *s: torch.randn(*s, dtype=torch.bfloat16) * 0.05)(Hq * Dh, D) * ((Hq * Dh) ** -0.5)),
    }

def reference(x, k_cache, v_cache, wq, wo):
    B, Sq, D = x.shape
    Hq, Dh = 16, 256
    Hkv = k_cache.shape[1]
    rep = Hq // Hkv
    q = (lambda x, *d: x.permute(*d))((x @ wq).reshape(B, Sq, Hq, Dh), 0, 2, 1, 3)
    k = (lambda x, n, axis: torch.repeat_interleave(x, n, dim=axis))(k_cache, rep, axis=1)
    v = (lambda x, n, axis: torch.repeat_interleave(x, n, dim=axis))(v_cache, rep, axis=1)
    scores = torch.einsum("bhqd,bhkd->bhqk", q, k) * (Dh ** -0.5)
    p = _softmax(scores, axis=-1)
    o = torch.einsum("bhqk,bhkd->bhqd", p, v)
    return (lambda x, *d: x.permute(*d))(o, 0, 2, 1, 3).reshape(B, Sq, Hq * Dh) @ wo
```

```asm
; @launch kernel=standalone__gqa_block_cached__near_ridge_kernel grid=(256,1,1) block=(512,1,1) lds=163840
; @launch kernel=gqa_reduce_kernel grid=(256,1,1) block=(256,1,1) lds=0
.amdgcn_target "amdgcn-amd-amdhsa--gfx950"
.text
.globl standalone__gqa_block_cached__near_ridge_kernel
.p2align 8
.type standalone__gqa_block_cached__near_ridge_kernel,@function
standalone__gqa_block_cached__near_ridge_kernel:
s_cmp_ge_u32 s2, 256
s_cbranch_scc1 L_end
s_load_dwordx8 s[40:47], s[0:1], 0
s_load_dwordx8 s[48:55], s[0:1], 32
s_and_b32 s3, s2, 7
s_lshr_b32 s4, s2, 3
s_and_b32 s4, s4, 15
s_lshr_b32 s5, s2, 7
s_lshl_b32 s6, s3, 1
s_add_u32 s5, s5, s6
v_lshrrev_b32 v1, 6, v0
v_and_b32 v2, 63, v0
v_and_b32 v3, 15, v2
v_readfirstlane_b32 s6, v1
v_lshrrev_b32 v4, 4, v2
s_and_b32 s7, s6, 3
s_mul_i32 s58, s7, 24064
s_add_u32 s58, s58, 67584
s_lshl_b32 s56, s4, 3
s_add_u32 s56, s56, s3
s_mul_i32 s56, s56, 24576
s_cmp_ge_u32 s4, 7
s_cselect_b32 s61, 7, 0
s_sub_u32 s62, s4, s61
s_cmp_ge_u32 s62, 7
s_cselect_b32 s61, 7, 0
s_sub_u32 s62, s62, s61
s_and_b32 s63, s4, 3
s_waitcnt lgkmcnt(0)
s_cmp_ge_u32 s6, 4
s_cbranch_scc1 L_loader
v_lshrrev_b32 v17, 2, v3
v_and_b32 v18, 3, v3
v_lshlrev_b32 v18, 3, v18
v_add_u32 v18, s58, v18
v_lshrrev_b32 v19, 1, v17
v_and_b32 v24, 1, v4
v_lshl_add_u32 v19, v24, 1, v19
v_lshl_add_u32 v24, v4, 3, v17
v_lshl_add_u32 v24, v24, 7, v18
v_xor_b32 v25, 0, v19
v_lshl_add_u32 v20, v25, 5, v24
v_xor_b32 v25, 1, v19
v_lshl_add_u32 v21, v25, 5, v24
v_xor_b32 v25, 2, v19
v_lshl_add_u32 v22, v25, 5, v24
v_xor_b32 v25, 3, v19
v_lshl_add_u32 v23, v25, 5, v24
v_lshrrev_b32 v24, 1, v4
v_lshl_add_u32 v24, v24, 4, v17
v_and_b32 v25, 1, v4
v_lshl_add_u32 v24, v25, 2, v24
v_mul_u32_u24 v28, 224, v24
v_add_u32 v28, v28, v18
v_lshrrev_b32 v10, 1, v3
v_xor_b32 v10, v10, v4
v_lshlrev_b32 v10, 4, v10
v_lshl_add_u32 v10, v3, 7, v10
v_xor_b32 v11, 64, v10
v_add_u32 v16, s58, v10
v_xor_b32 v17, 64, v16
v_lshlrev_b32 v29, 4, v2
v_lshlrev_b32 v30, 3, v2
v_mov_b32 v32, 0
v_mov_b32 v33, 0
v_mov_b32 v34, 0
v_mov_b32 v35, 0
v_mov_b32 v36, 0
v_mov_b32 v37, 0
v_mov_b32 v38, 0
v_mov_b32 v39, 0
v_mov_b32 v40, 0
v_mov_b32 v41, 0
v_mov_b32 v42, 0
v_mov_b32 v43, 0
v_mov_b32 v44, 0
v_mov_b32 v45, 0
v_mov_b32 v46, 0
v_mov_b32 v47, 0
v_mov_b32 v48, 0
v_mov_b32 v49, 0
v_mov_b32 v50, 0
v_mov_b32 v51, 0
v_mov_b32 v52, 0
v_mov_b32 v53, 0
v_mov_b32 v54, 0
v_mov_b32 v55, 0
v_mov_b32 v56, 0
v_mov_b32 v57, 0
v_mov_b32 v58, 0
v_mov_b32 v59, 0
v_mov_b32 v60, 0
v_mov_b32 v61, 0
v_mov_b32 v62, 0
v_mov_b32 v63, 0
v_mov_b32 v64, 0
v_mov_b32 v65, 0
v_mov_b32 v66, 0
v_mov_b32 v67, 0
v_mov_b32 v68, 0
v_mov_b32 v69, 0
v_mov_b32 v70, 0
v_mov_b32 v71, 0
v_mov_b32 v72, 0
v_mov_b32 v73, 0
v_mov_b32 v74, 0
v_mov_b32 v75, 0
v_mov_b32 v76, 0
v_mov_b32 v77, 0
v_mov_b32 v78, 0
v_mov_b32 v79, 0
s_mov_b32 s59, 0
s_mul_i32 s60, s62, 6144
s_barrier
v_add_u32 v12, s59, v20
v_add_u32 v13, s59, v21
v_add_u32 v14, s59, v22
v_add_u32 v15, s59, v23
v_add_u32 v18, s60, v10
ds_read_b128 v[80:83], v18 offset:0
ds_read_b128 v[84:87], v18 offset:2048
ds_read_b128 v[88:91], v18 offset:4096
ds_read_b64_tr_b16 v[104:105], v12 offset:0
ds_read_b64_tr_b16 v[106:107], v12 offset:512
ds_read_b64_tr_b16 v[108:109], v13 offset:0
ds_read_b64_tr_b16 v[110:111], v13 offset:512
ds_read_b64_tr_b16 v[112:113], v14 offset:0
ds_read_b64_tr_b16 v[114:115], v14 offset:512
ds_read_b64_tr_b16 v[116:117], v15 offset:0
ds_read_b64_tr_b16 v[118:119], v15 offset:512
s_add_u32 s59, s59, 4096
s_cmp_eq_u32 s59, 20480
s_cselect_b32 s59, 0, s59
s_waitcnt lgkmcnt(0)
s_mov_b32 s64, 6
L_loopA:
s_barrier
v_add_u32 v12, s59, v20
v_add_u32 v13, s59, v21
v_add_u32 v14, s59, v22
v_add_u32 v15, s59, v23
v_add_u32 v18, s60, v11
v_mfma_f32_16x16x32_bf16 v[32:35], v[104:107], v[80:83], v[32:35]
ds_read_b128 v[92:95], v18 offset:0
v_mfma_f32_16x16x32_bf16 v[36:39], v[104:107], v[84:87], v[36:39]
ds_read_b128 v[96:99], v18 offset:2048
v_mfma_f32_16x16x32_bf16 v[40:43], v[104:107], v[88:91], v[40:43]
ds_read_b128 v[100:103], v18 offset:4096
v_mfma_f32_16x16x32_bf16 v[44:47], v[108:111], v[80:83], v[44:47]
ds_read_b64_tr_b16 v[120:121], v12 offset:0
v_mfma_f32_16x16x32_bf16 v[48:51], v[108:111], v[84:87], v[48:51]
ds_read_b64_tr_b16 v[122:123], v12 offset:512
v_mfma_f32_16x16x32_bf16 v[52:55], v[108:111], v[88:91], v[52:55]
ds_read_b64_tr_b16 v[124:125], v13 offset:0
v_mfma_f32_16x16x32_bf16 v[56:59], v[112:115], v[80:83], v[56:59]
ds_read_b64_tr_b16 v[126:127], v13 offset:512
v_mfma_f32_16x16x32_bf16 v[60:63], v[112:115], v[84:87], v[60:63]
ds_read_b64_tr_b16 v[128:129], v14 offset:0
v_mfma_f32_16x16x32_bf16 v[64:67], v[112:115], v[88:91], v[64:67]
ds_read_b64_tr_b16 v[130:131], v14 offset:512
v_mfma_f32_16x16x32_bf16 v[68:71], v[116:119], v[80:83], v[68:71]
ds_read_b64_tr_b16 v[132:133], v15 offset:0
v_mfma_f32_16x16x32_bf16 v[72:75], v[116:119], v[84:87], v[72:75]
ds_read_b64_tr_b16 v[134:135], v15 offset:512
v_mfma_f32_16x16x32_bf16 v[76:79], v[116:119], v[88:91], v[76:79]
s_add_u32 s59, s59, 4096
s_cmp_eq_u32 s59, 20480
s_cselect_b32 s59, 0, s59
s_add_u32 s60, s60, 6144
s_cmp_eq_u32 s60, 43008
s_cselect_b32 s60, 0, s60
s_waitcnt lgkmcnt(0)
s_barrier
v_add_u32 v12, s59, v20
v_add_u32 v13, s59, v21
v_add_u32 v14, s59, v22
v_add_u32 v15, s59, v23
v_add_u32 v18, s60, v10
v_mfma_f32_16x16x32_bf16 v[32:35], v[120:123], v[92:95], v[32:35]
ds_read_b128 v[80:83], v18 offset:0
v_mfma_f32_16x16x32_bf16 v[36:39], v[120:123], v[96:99], v[36:39]
ds_read_b128 v[84:87], v18 offset:2048
v_mfma_f32_16x16x32_bf16 v[40:43], v[120:123], v[100:103], v[40:43]
ds_read_b128 v[88:91], v18 offset:4096
v_mfma_f32_16x16x32_bf16 v[44:47], v[124:127], v[92:95], v[44:47]
ds_read_b64_tr_b16 v[104:105], v12 offset:0
v_mfma_f32_16x16x32_bf16 v[48:51], v[124:127], v[96:99], v[48:51]
ds_read_b64_tr_b16 v[106:107], v12 offset:512
v_mfma_f32_16x16x32_bf16 v[52:55], v[124:127], v[100:103], v[52:55]
ds_read_b64_tr_b16 v[108:109], v13 offset:0
v_mfma_f32_16x16x32_bf16 v[56:59], v[128:131], v[92:95], v[56:59]
ds_read_b64_tr_b16 v[110:111], v13 offset:512
v_mfma_f32_16x16x32_bf16 v[60:63], v[128:131], v[96:99], v[60:63]
ds_read_b64_tr_b16 v[112:113], v14 offset:0
v_mfma_f32_16x16x32_bf16 v[64:67], v[128:131], v[100:103], v[64:67]
ds_read_b64_tr_b16 v[114:115], v14 offset:512
v_mfma_f32_16x16x32_bf16 v[68:71], v[132:135], v[92:95], v[68:71]
ds_read_b64_tr_b16 v[116:117], v15 offset:0
v_mfma_f32_16x16x32_bf16 v[72:75], v[132:135], v[96:99], v[72:75]
ds_read_b64_tr_b16 v[118:119], v15 offset:512
v_mfma_f32_16x16x32_bf16 v[76:79], v[132:135], v[100:103], v[76:79]
s_add_u32 s59, s59, 4096
s_cmp_eq_u32 s59, 20480
s_cselect_b32 s59, 0, s59
s_sub_u32 s64, s64, 1
s_waitcnt lgkmcnt(0)
s_cmp_lg_u32 s64, 0
s_cbranch_scc1 L_loopA
s_barrier
v_add_u32 v12, s59, v20
v_add_u32 v13, s59, v21
v_add_u32 v14, s59, v22
v_add_u32 v15, s59, v23
v_add_u32 v18, s60, v11
v_mfma_f32_16x16x32_bf16 v[32:35], v[104:107], v[80:83], v[32:35]
ds_read_b128 v[92:95], v18 offset:0
v_mfma_f32_16x16x32_bf16 v[36:39], v[104:107], v[84:87], v[36:39]
ds_read_b128 v[96:99], v18 offset:2048
v_mfma_f32_16x16x32_bf16 v[40:43], v[104:107], v[88:91], v[40:43]
ds_read_b128 v[100:103], v18 offset:4096
v_mfma_f32_16x16x32_bf16 v[44:47], v[108:111], v[80:83], v[44:47]
ds_read_b64_tr_b16 v[120:121], v12 offset:0
v_mfma_f32_16x16x32_bf16 v[48:51], v[108:111], v[84:87], v[48:51]
ds_read_b64_tr_b16 v[122:123], v12 offset:512
v_mfma_f32_16x16x32_bf16 v[52:55], v[108:111], v[88:91], v[52:55]
ds_read_b64_tr_b16 v[124:125], v13 offset:0
v_mfma_f32_16x16x32_bf16 v[56:59], v[112:115], v[80:83], v[56:59]
ds_read_b64_tr_b16 v[126:127], v13 offset:512
v_mfma_f32_16x16x32_bf16 v[60:63], v[112:115], v[84:87], v[60:63]
ds_read_b64_tr_b16 v[128:129], v14 offset:0
v_mfma_f32_16x16x32_bf16 v[64:67], v[112:115], v[88:91], v[64:67]
ds_read_b64_tr_b16 v[130:131], v14 offset:512
v_mfma_f32_16x16x32_bf16 v[68:71], v[116:119], v[80:83], v[68:71]
ds_read_b64_tr_b16 v[132:133], v15 offset:0
v_mfma_f32_16x16x32_bf16 v[72:75], v[116:119], v[84:87], v[72:75]
ds_read_b64_tr_b16 v[134:135], v15 offset:512
v_mfma_f32_16x16x32_bf16 v[76:79], v[116:119], v[88:91], v[76:79]
s_add_u32 s59, s59, 4096
s_cmp_eq_u32 s59, 20480
s_cselect_b32 s59, 0, s59
s_add_u32 s60, s60, 6144
s_cmp_eq_u32 s60, 43008
s_cselect_b32 s60, 0, s60
s_waitcnt lgkmcnt(0)
s_barrier
ds_read_b128 v[136:139], v16 offset:16384
ds_read_b128 v[140:143], v17 offset:16384
ds_read_b128 v[144:147], v16 offset:18432
ds_read_b128 v[148:151], v17 offset:18432
ds_read_b128 v[152:155], v16 offset:20480
ds_read_b128 v[156:159], v17 offset:20480
v_mfma_f32_16x16x32_bf16 v[32:35], v[120:123], v[92:95], v[32:35]
v_mfma_f32_16x16x32_bf16 v[36:39], v[120:123], v[96:99], v[36:39]
v_mfma_f32_16x16x32_bf16 v[40:43], v[120:123], v[100:103], v[40:43]
v_mfma_f32_16x16x32_bf16 v[44:47], v[124:127], v[92:95], v[44:47]
v_mfma_f32_16x16x32_bf16 v[48:51], v[124:127], v[96:99], v[48:51]
v_mfma_f32_16x16x32_bf16 v[52:55], v[124:127], v[100:103], v[52:55]
v_mfma_f32_16x16x32_bf16 v[56:59], v[128:131], v[92:95], v[56:59]
v_mfma_f32_16x16x32_bf16 v[60:63], v[128:131], v[96:99], v[60:63]
v_mfma_f32_16x16x32_bf16 v[64:67], v[128:131], v[100:103], v[64:67]
v_mfma_f32_16x16x32_bf16 v[68:71], v[132:135], v[92:95], v[68:71]
v_mfma_f32_16x16x32_bf16 v[72:75], v[132:135], v[96:99], v[72:75]
v_mfma_f32_16x16x32_bf16 v[76:79], v[132:135], v[100:103], v[76:79]
s_nop 7
s_nop 1
v_cvt_pk_bf16_f32 v160, v32, v33
v_cvt_pk_bf16_f32 v161, v34, v35
v_cvt_pk_bf16_f32 v162, v44, v45
v_cvt_pk_bf16_f32 v163, v46, v47
v_cvt_pk_bf16_f32 v164, v36, v37
v_cvt_pk_bf16_f32 v165, v38, v39
v_cvt_pk_bf16_f32 v166, v48, v49
v_cvt_pk_bf16_f32 v167, v50, v51
v_cvt_pk_bf16_f32 v168, v40, v41
v_cvt_pk_bf16_f32 v169, v42, v43
v_cvt_pk_bf16_f32 v170, v52, v53
v_cvt_pk_bf16_f32 v171, v54, v55
v_cvt_pk_bf16_f32 v172, v56, v57
v_cvt_pk_bf16_f32 v173, v58, v59
v_cvt_pk_bf16_f32 v174, v68, v69
v_cvt_pk_bf16_f32 v175, v70, v71
v_cvt_pk_bf16_f32 v176, v60, v61
v_cvt_pk_bf16_f32 v177, v62, v63
v_cvt_pk_bf16_f32 v178, v72, v73
v_cvt_pk_bf16_f32 v179, v74, v75
v_cvt_pk_bf16_f32 v180, v64, v65
v_cvt_pk_bf16_f32 v181, v66, v67
v_cvt_pk_bf16_f32 v182, v76, v77
v_cvt_pk_bf16_f32 v183, v78, v79
s_nop 1
v_permlane32_swap_b32 v160, v162
v_permlane32_swap_b32 v161, v163
v_permlane32_swap_b32 v164, v166
v_permlane32_swap_b32 v165, v167
v_permlane32_swap_b32 v168, v170
v_permlane32_swap_b32 v169, v171
v_permlane32_swap_b32 v172, v174
v_permlane32_swap_b32 v173, v175
v_permlane32_swap_b32 v176, v178
v_permlane32_swap_b32 v177, v179
v_permlane32_swap_b32 v180, v182
v_permlane32_swap_b32 v181, v183
v_permlane16_swap_b32 v160, v162
v_permlane16_swap_b32 v161, v163
v_permlane16_swap_b32 v164, v166
v_permlane16_swap_b32 v165, v167
v_permlane16_swap_b32 v168, v170
v_permlane16_swap_b32 v169, v171
v_permlane16_swap_b32 v172, v174
v_permlane16_swap_b32 v173, v175
v_permlane16_swap_b32 v176, v178
v_permlane16_swap_b32 v177, v179
v_permlane16_swap_b32 v180, v182
v_permlane16_swap_b32 v181, v183
s_mul_i32 s64, s7, 9216
v_add_u32 v31, s64, v29
s_waitcnt lgkmcnt(0)
v_mfma_f32_16x16x32_bf16 v[184:187], v[136:139], v[160:163], 0
v_mfma_f32_16x16x32_bf16 v[188:191], v[136:139], v[164:167], 0
v_mfma_f32_16x16x32_bf16 v[192:195], v[136:139], v[168:171], 0
v_mfma_f32_16x16x32_bf16 v[196:199], v[144:147], v[160:163], 0
v_mfma_f32_16x16x32_bf16 v[200:203], v[144:147], v[164:167], 0
v_mfma_f32_16x16x32_bf16 v[204:207], v[144:147], v[168:171], 0
v_mfma_f32_16x16x32_bf16 v[208:211], v[152:155], v[160:163], 0
v_mfma_f32_16x16x32_bf16 v[212:215], v[152:155], v[164:167], 0
v_mfma_f32_16x16x32_bf16 v[216:219], v[152:155], v[168:171], 0
v_mfma_f32_16x16x32_bf16 v[184:187], v[140:143], v[172:175], v[184:187]
v_mfma_f32_16x16x32_bf16 v[188:191], v[140:143], v[176:179], v[188:191]
v_mfma_f32_16x16x32_bf16 v[192:195], v[140:143], v[180:183], v[192:195]
v_mfma_f32_16x16x32_bf16 v[196:199], v[148:151], v[172:175], v[196:199]
v_mfma_f32_16x16x32_bf16 v[200:203], v[148:151], v[176:179], v[200:203]
v_mfma_f32_16x16x32_bf16 v[204:207], v[148:151], v[180:183], v[204:207]
v_mfma_f32_16x16x32_bf16 v[208:211], v[156:159], v[172:175], v[208:211]
v_mfma_f32_16x16x32_bf16 v[212:215], v[156:159], v[176:179], v[212:215]
v_mfma_f32_16x16x32_bf16 v[216:219], v[156:159], v[180:183], v[216:219]
s_nop 1
ds_write_b128 v31, v[184:187] offset:0
ds_write_b128 v31, v[188:191] offset:1024
ds_write_b128 v31, v[192:195] offset:2048
ds_write_b128 v31, v[196:199] offset:3072
ds_write_b128 v31, v[200:203] offset:4096
ds_write_b128 v31, v[204:207] offset:5120
ds_write_b128 v31, v[208:211] offset:6144
ds_write_b128 v31, v[212:215] offset:7168
ds_write_b128 v31, v[216:219] offset:8192
s_waitcnt lgkmcnt(0)
s_barrier
s_cmp_ge_u32 s7, 3
s_cbranch_scc1 L_smdone
s_lshl_b32 s64, s7, 10
v_add_u32 v31, s64, v29
ds_read_b128 v[32:35], v31 offset:0
ds_read_b128 v[36:39], v31 offset:3072
ds_read_b128 v[40:43], v31 offset:6144
ds_read_b128 v[44:47], v31 offset:9216
ds_read_b128 v[48:51], v31 offset:12288
ds_read_b128 v[52:55], v31 offset:15360
ds_read_b128 v[56:59], v31 offset:18432
ds_read_b128 v[60:63], v31 offset:21504
ds_read_b128 v[64:67], v31 offset:24576
ds_read_b128 v[68:71], v31 offset:27648
ds_read_b128 v[72:75], v31 offset:30720
ds_read_b128 v[76:79], v31 offset:33792
s_mov_b32 s64, 0x3db8aa3b
s_waitcnt lgkmcnt(0)
v_add_f32 v32, v32, v44
v_add_f32 v33, v33, v45
v_add_f32 v34, v34, v46
v_add_f32 v35, v35, v47
v_add_f32 v36, v36, v48
v_add_f32 v37, v37, v49
v_add_f32 v38, v38, v50
v_add_f32 v39, v39, v51
v_add_f32 v40, v40, v52
v_add_f32 v41, v41, v53
v_add_f32 v42, v42, v54
v_add_f32 v43, v43, v55
v_add_f32 v32, v32, v56
v_add_f32 v33, v33, v57
v_add_f32 v34, v34, v58
v_add_f32 v35, v35, v59
v_add_f32 v36, v36, v60
v_add_f32 v37, v37, v61
v_add_f32 v38, v38, v62
v_add_f32 v39, v39, v63
v_add_f32 v40, v40, v64
v_add_f32 v41, v41, v65
v_add_f32 v42, v42, v66
v_add_f32 v43, v43, v67
v_add_f32 v32, v32, v68
v_add_f32 v33, v33, v69
v_add_f32 v34, v34, v70
v_add_f32 v35, v35, v71
v_add_f32 v36, v36, v72
v_add_f32 v37, v37, v73
v_add_f32 v38, v38, v74
v_add_f32 v39, v39, v75
v_add_f32 v40, v40, v76
v_add_f32 v41, v41, v77
v_add_f32 v42, v42, v78
v_add_f32 v43, v43, v79
v_cvt_pk_bf16_f32 v44, v32, v33
v_cvt_pk_bf16_f32 v45, v34, v35
v_cvt_pk_bf16_f32 v46, v36, v37
v_cvt_pk_bf16_f32 v47, v38, v39
v_cvt_pk_bf16_f32 v48, v40, v41
v_cvt_pk_bf16_f32 v49, v42, v43
v_lshlrev_b32 v32, 16, v44
v_and_b32 v33, 0xffff0000, v44
v_lshlrev_b32 v34, 16, v45
v_and_b32 v35, 0xffff0000, v45
v_lshlrev_b32 v36, 16, v46
v_and_b32 v37, 0xffff0000, v46
v_lshlrev_b32 v38, 16, v47
v_and_b32 v39, 0xffff0000, v47
v_lshlrev_b32 v40, 16, v48
v_and_b32 v41, 0xffff0000, v48
v_lshlrev_b32 v42, 16, v49
v_and_b32 v43, 0xffff0000, v49
v_max3_f32 v56, v32, v33, v34
v_max3_f32 v57, v35, v36, v37
v_max3_f32 v58, v38, v39, v40
v_max3_f32 v59, v41, v42, v43
v_max3_f32 v56, v56, v57, v58
v_max_f32 v56, v56, v59
v_mov_b32 v57, v56
s_nop 1
v_permlane32_swap_b32 v56, v57
v_max_f32 v56, v56, v57
v_mov_b32 v57, v56
s_nop 1
v_permlane16_swap_b32 v56, v57
v_max_f32 v56, v56, v57
v_mul_f32 v56, s64, v56
v_fma_f32 v32, v32, s64, -v56
v_fma_f32 v33, v33, s64, -v56
v_fma_f32 v34, v34, s64, -v56
v_fma_f32 v35, v35, s64, -v56
v_fma_f32 v36, v36, s64, -v56
v_fma_f32 v37, v37, s64, -v56
v_fma_f32 v38, v38, s64, -v56
v_fma_f32 v39, v39, s64, -v56
v_fma_f32 v40, v40, s64, -v56
v_fma_f32 v41, v41, s64, -v56
v_fma_f32 v42, v42, s64, -v56
v_fma_f32 v43, v43, s64, -v56
v_exp_f32 v32, v32
v_exp_f32 v33, v33
v_exp_f32 v34, v34
v_exp_f32 v35, v35
v_exp_f32 v36, v36
v_exp_f32 v37, v37
v_exp_f32 v38, v38
v_exp_f32 v39, v39
v_exp_f32 v40, v40
v_exp_f32 v41, v41
v_exp_f32 v42, v42
v_exp_f32 v43, v43
s_nop 0
v_add_f32 v58, v32, v33
v_add_f32 v58, v58, v34
v_add_f32 v58, v58, v35
v_add_f32 v58, v58, v36
v_add_f32 v58, v58, v37
v_add_f32 v58, v58, v38
v_add_f32 v58, v58, v39
v_add_f32 v58, v58, v40
v_add_f32 v58, v58, v41
v_add_f32 v58, v58, v42
v_add_f32 v58, v58, v43
v_mov_b32 v59, v58
s_nop 1
v_permlane32_swap_b32 v58, v59
v_add_f32 v58, v58, v59
v_mov_b32 v59, v58
s_nop 1
v_permlane16_swap_b32 v58, v59
v_add_f32 v58, v58, v59
v_rcp_f32 v58, v58
s_mul_i32 s64, s7, 1536
v_mul_f32 v32, v32, v58
v_mul_f32 v33, v33, v58
v_mul_f32 v34, v34, v58
v_mul_f32 v35, v35, v58
v_mul_f32 v36, v36, v58
v_mul_f32 v37, v37, v58
v_mul_f32 v38, v38, v58
v_mul_f32 v39, v39, v58
v_mul_f32 v40, v40, v58
v_mul_f32 v41, v41, v58
v_mul_f32 v42, v42, v58
v_mul_f32 v43, v43, v58
v_cvt_pk_bf16_f32 v44, v32, v33
v_cvt_pk_bf16_f32 v45, v34, v35
v_cvt_pk_bf16_f32 v46, v36, v37
v_cvt_pk_bf16_f32 v47, v38, v39
v_cvt_pk_bf16_f32 v48, v40, v41
v_cvt_pk_bf16_f32 v49, v42, v43
v_add_u32 v31, s64, v29
ds_write_b128 v31, v[44:47] offset:36864
v_add_u32 v31, s64, v30
ds_write_b64 v31, v[48:49] offset:37888
s_waitcnt lgkmcnt(0)
L_smdone:
s_barrier
s_mov_b32 s59, 0
s_mul_i32 s60, s63, 6144
s_add_u32 s60, s60, 43008
v_add_u32 v13, s59, v28
v_add_u32 v12, s60, v10
ds_read_b128 v[116:119], v12 offset:0
ds_read_b128 v[120:123], v12 offset:2048
ds_read_b128 v[124:127], v12 offset:4096
ds_read_b64_tr_b16 v[140:141], v13 offset:0
ds_read_b64_tr_b16 v[142:143], v13 offset:1792
ds_read_b64_tr_b16 v[144:145], v13 offset:32
ds_read_b64_tr_b16 v[146:147], v13 offset:1824
ds_read_b64_tr_b16 v[148:149], v13 offset:64
ds_read_b64_tr_b16 v[150:151], v13 offset:1856
ds_read_b64_tr_b16 v[152:153], v13 offset:96
ds_read_b64_tr_b16 v[154:155], v13 offset:1888
ds_read_b64_tr_b16 v[156:157], v13 offset:128
ds_read_b64_tr_b16 v[158:159], v13 offset:1920
ds_read_b64_tr_b16 v[160:161], v13 offset:160
ds_read_b64_tr_b16 v[162:163], v13 offset:1952
ds_read_b64_tr_b16 v[164:165], v13 offset:192
ds_read_b64_tr_b16 v[166:167], v13 offset:1984
s_add_u32 s59, s59, 7168
s_cmp_eq_u32 s59, 21504
s_cselect_b32 s59, 0, s59
s_waitcnt lgkmcnt(0)
s_barrier
v_add_u32 v13, s59, v28
v_add_u32 v12, s60, v11
v_mfma_f32_16x16x32_bf16 v[32:35], v[116:119], v[140:143], 0
ds_read_b128 v[128:131], v12 offset:0
v_mfma_f32_16x16x32_bf16 v[36:39], v[120:123], v[140:143], 0
ds_read_b128 v[132:135], v12 offset:2048
v_mfma_f32_16x16x32_bf16 v[40:43], v[124:127], v[140:143], 0
ds_read_b128 v[136:139], v12 offset:4096
v_mfma_f32_16x16x32_bf16 v[44:47], v[116:119], v[144:147], 0
ds_read_b64_tr_b16 v[168:169], v13 offset:0
v_mfma_f32_16x16x32_bf16 v[48:51], v[120:123], v[144:147], 0
ds_read_b64_tr_b16 v[170:171], v13 offset:1792
v_mfma_f32_16x16x32_bf16 v[52:55], v[124:127], v[144:147], 0
ds_read_b64_tr_b16 v[172:173], v13 offset:32
v_mfma_f32_16x16x32_bf16 v[56:59], v[116:119], v[148:151], 0
ds_read_b64_tr_b16 v[174:175], v13 offset:1824
v_mfma_f32_16x16x32_bf16 v[60:63], v[120:123], v[148:151], 0
ds_read_b64_tr_b16 v[176:177], v13 offset:64
v_mfma_f32_16x16x32_bf16 v[64:67], v[124:127], v[148:151], 0
ds_read_b64_tr_b16 v[178:179], v13 offset:1856
v_mfma_f32_16x16x32_bf16 v[68:71], v[116:119], v[152:155], 0
ds_read_b64_tr_b16 v[180:181], v13 offset:96
v_mfma_f32_16x16x32_bf16 v[72:75], v[120:123], v[152:155], 0
ds_read_b64_tr_b16 v[182:183], v13 offset:1888
v_mfma_f32_16x16x32_bf16 v[76:79], v[124:127], v[152:155], 0
ds_read_b64_tr_b16 v[184:185], v13 offset:128
v_mfma_f32_16x16x32_bf16 v[80:83], v[116:119], v[156:159], 0
ds_read_b64_tr_b16 v[186:187], v13 offset:1920
v_mfma_f32_16x16x32_bf16 v[84:87], v[120:123], v[156:159], 0
ds_read_b64_tr_b16 v[188:189], v13 offset:160
v_mfma_f32_16x16x32_bf16 v[88:91], v[124:127], v[156:159], 0
ds_read_b64_tr_b16 v[190:191], v13 offset:1952
v_mfma_f32_16x16x32_bf16 v[92:95], v[116:119], v[160:163], 0
ds_read_b64_tr_b16 v[192:193], v13 offset:192
v_mfma_f32_16x16x32_bf16 v[96:99], v[120:123], v[160:163], 0
ds_read_b64_tr_b16 v[194:195], v13 offset:1984
v_mfma_f32_16x16x32_bf16 v[100:103], v[124:127], v[160:163], 0
v_mfma_f32_16x16x32_bf16 v[104:107], v[116:119], v[164:167], 0
v_mfma_f32_16x16x32_bf16 v[108:111], v[120:123], v[164:167], 0
v_mfma_f32_16x16x32_bf16 v[112:115], v[124:127], v[164:167], 0
s_add_u32 s60, s60, 6144
s_cmp_eq_u32 s60, 67584
s_cselect_b32 s60, 43008, s60
s_add_u32 s59, s59, 7168
s_cmp_eq_u32 s59, 21504
s_cselect_b32 s59, 0, s59
s_waitcnt lgkmcnt(0)
s_mov_b32 s64, 3
L_loopD:
s_barrier
v_add_u32 v13, s59, v28
v_add_u32 v12, s60, v10
v_mfma_f32_16x16x32_bf16 v[32:35], v[128:131], v[168:171], v[32:35]
ds_read_b128 v[116:119], v12 offset:0
v_mfma_f32_16x16x32_bf16 v[36:39], v[132:135], v[168:171], v[36:39]
ds_read_b128 v[120:123], v12 offset:2048
v_mfma_f32_16x16x32_bf16 v[40:43], v[136:139], v[168:171], v[40:43]
ds_read_b128 v[124:127], v12 offset:4096
v_mfma_f32_16x16x32_bf16 v[44:47], v[128:131], v[172:175], v[44:47]
ds_read_b64_tr_b16 v[140:141], v13 offset:0
v_mfma_f32_16x16x32_bf16 v[48:51], v[132:135], v[172:175], v[48:51]
ds_read_b64_tr_b16 v[142:143], v13 offset:1792
v_mfma_f32_16x16x32_bf16 v[52:55], v[136:139], v[172:175], v[52:55]
ds_read_b64_tr_b16 v[144:145], v13 offset:32
v_mfma_f32_16x16x32_bf16 v[56:59], v[128:131], v[176:179], v[56:59]
ds_read_b64_tr_b16 v[146:147], v13 offset:1824
v_mfma_f32_16x16x32_bf16 v[60:63], v[132:135], v[176:179], v[60:63]
ds_read_b64_tr_b16 v[148:149], v13 offset:64
v_mfma_f32_16x16x32_bf16 v[64:67], v[136:139], v[176:179], v[64:67]
ds_read_b64_tr_b16 v[150:151], v13 offset:1856
v_mfma_f32_16x16x32_bf16 v[68:71], v[128:131], v[180:183], v[68:71]
ds_read_b64_tr_b16 v[152:153], v13 offset:96
v_mfma_f32_16x16x32_bf16 v[72:75], v[132:135], v[180:183], v[72:75]
ds_read_b64_tr_b16 v[154:155], v13 offset:1888
v_mfma_f32_16x16x32_bf16 v[76:79], v[136:139], v[180:183], v[76:79]
ds_read_b64_tr_b16 v[156:157], v13 offset:128
v_mfma_f32_16x16x32_bf16 v[80:83], v[128:131], v[184:187], v[80:83]
ds_read_b64_tr_b16 v[158:159], v13 offset:1920
v_mfma_f32_16x16x32_bf16 v[84:87], v[132:135], v[184:187], v[84:87]
ds_read_b64_tr_b16 v[160:161], v13 offset:160
v_mfma_f32_16x16x32_bf16 v[88:91], v[136:139], v[184:187], v[88:91]
ds_read_b64_tr_b16 v[162:163], v13 offset:1952
v_mfma_f32_16x16x32_bf16 v[92:95], v[128:131], v[188:191], v[92:95]
ds_read_b64_tr_b16 v[164:165], v13 offset:192
v_mfma_f32_16x16x32_bf16 v[96:99], v[132:135], v[188:191], v[96:99]
ds_read_b64_tr_b16 v[166:167], v13 offset:1984
v_mfma_f32_16x16x32_bf16 v[100:103], v[136:139], v[188:191], v[100:103]
v_mfma_f32_16x16x32_bf16 v[104:107], v[128:131], v[192:195], v[104:107]
v_mfma_f32_16x16x32_bf16 v[108:111], v[132:135], v[192:195], v[108:111]
v_mfma_f32_16x16x32_bf16 v[112:115], v[136:139], v[192:195], v[112:115]
s_add_u32 s59, s59, 7168
s_cmp_eq_u32 s59, 21504
s_cselect_b32 s59, 0, s59
s_waitcnt lgkmcnt(0)
s_barrier
v_add_u32 v13, s59, v28
v_add_u32 v12, s60, v11
v_mfma_f32_16x16x32_bf16 v[32:35], v[116:119], v[140:143], v[32:35]
ds_read_b128 v[128:131], v12 offset:0
v_mfma_f32_16x16x32_bf16 v[36:39], v[120:123], v[140:143], v[36:39]
ds_read_b128 v[132:135], v12 offset:2048
v_mfma_f32_16x16x32_bf16 v[40:43], v[124:127], v[140:143], v[40:43]
ds_read_b128 v[136:139], v12 offset:4096
v_mfma_f32_16x16x32_bf16 v[44:47], v[116:119], v[144:147], v[44:47]
ds_read_b64_tr_b16 v[168:169], v13 offset:0
v_mfma_f32_16x16x32_bf16 v[48:51], v[120:123], v[144:147], v[48:51]
ds_read_b64_tr_b16 v[170:171], v13 offset:1792
v_mfma_f32_16x16x32_bf16 v[52:55], v[124:127], v[144:147], v[52:55]
ds_read_b64_tr_b16 v[172:173], v13 offset:32
v_mfma_f32_16x16x32_bf16 v[56:59], v[116:119], v[148:151], v[56:59]
ds_read_b64_tr_b16 v[174:175], v13 offset:1824
v_mfma_f32_16x16x32_bf16 v[60:63], v[120:123], v[148:151], v[60:63]
ds_read_b64_tr_b16 v[176:177], v13 offset:64
v_mfma_f32_16x16x32_bf16 v[64:67], v[124:127], v[148:151], v[64:67]
ds_read_b64_tr_b16 v[178:179], v13 offset:1856
v_mfma_f32_16x16x32_bf16 v[68:71], v[116:119], v[152:155], v[68:71]
ds_read_b64_tr_b16 v[180:181], v13 offset:96
v_mfma_f32_16x16x32_bf16 v[72:75], v[120:123], v[152:155], v[72:75]
ds_read_b64_tr_b16 v[182:183], v13 offset:1888
v_mfma_f32_16x16x32_bf16 v[76:79], v[124:127], v[152:155], v[76:79]
ds_read_b64_tr_b16 v[184:185], v13 offset:128
v_mfma_f32_16x16x32_bf16 v[80:83], v[116:119], v[156:159], v[80:83]
ds_read_b64_tr_b16 v[186:187], v13 offset:1920
v_mfma_f32_16x16x32_bf16 v[84:87], v[120:123], v[156:159], v[84:87]
ds_read_b64_tr_b16 v[188:189], v13 offset:160
v_mfma_f32_16x16x32_bf16 v[88:91], v[124:127], v[156:159], v[88:91]
ds_read_b64_tr_b16 v[190:191], v13 offset:1952
v_mfma_f32_16x16x32_bf16 v[92:95], v[116:119], v[160:163], v[92:95]
ds_read_b64_tr_b16 v[192:193], v13 offset:192
v_mfma_f32_16x16x32_bf16 v[96:99], v[120:123], v[160:163], v[96:99]
ds_read_b64_tr_b16 v[194:195], v13 offset:1984
v_mfma_f32_16x16x32_bf16 v[100:103], v[124:127], v[160:163], v[100:103]
v_mfma_f32_16x16x32_bf16 v[104:107], v[116:119], v[164:167], v[104:107]
v_mfma_f32_16x16x32_bf16 v[108:111], v[120:123], v[164:167], v[108:111]
v_mfma_f32_16x16x32_bf16 v[112:115], v[124:127], v[164:167], v[112:115]
s_add_u32 s60, s60, 6144
s_cmp_eq_u32 s60, 67584
s_cselect_b32 s60, 43008, s60
s_add_u32 s59, s59, 7168
s_cmp_eq_u32 s59, 21504
s_cselect_b32 s59, 0, s59
s_sub_u32 s64, s64, 1
s_waitcnt lgkmcnt(0)
s_cmp_lg_u32 s64, 0
s_cbranch_scc1 L_loopD
ds_read_b128 v[196:199], v29 offset:36864
ds_read_b64 v[200:201], v30 offset:37888
ds_read_b128 v[202:205], v29 offset:38400
ds_read_b64 v[206:207], v30 offset:39424
ds_read_b128 v[208:211], v29 offset:39936
ds_read_b64 v[212:213], v30 offset:40960
v_mfma_f32_16x16x32_bf16 v[32:35], v[128:131], v[168:171], v[32:35]
v_mfma_f32_16x16x32_bf16 v[36:39], v[132:135], v[168:171], v[36:39]
v_mfma_f32_16x16x32_bf16 v[40:43], v[136:139], v[168:171], v[40:43]
v_mfma_f32_16x16x32_bf16 v[44:47], v[128:131], v[172:175], v[44:47]
v_mfma_f32_16x16x32_bf16 v[48:51], v[132:135], v[172:175], v[48:51]
v_mfma_f32_16x16x32_bf16 v[52:55], v[136:139], v[172:175], v[52:55]
v_mfma_f32_16x16x32_bf16 v[56:59], v[128:131], v[176:179], v[56:59]
v_mfma_f32_16x16x32_bf16 v[60:63], v[132:135], v[176:179], v[60:63]
v_mfma_f32_16x16x32_bf16 v[64:67], v[136:139], v[176:179], v[64:67]
v_mfma_f32_16x16x32_bf16 v[68:71], v[128:131], v[180:183], v[68:71]
v_mfma_f32_16x16x32_bf16 v[72:75], v[132:135], v[180:183], v[72:75]
v_mfma_f32_16x16x32_bf16 v[76:79], v[136:139], v[180:183], v[76:79]
v_mfma_f32_16x16x32_bf16 v[80:83], v[128:131], v[184:187], v[80:83]
v_mfma_f32_16x16x32_bf16 v[84:87], v[132:135], v[184:187], v[84:87]
v_mfma_f32_16x16x32_bf16 v[88:91], v[136:139], v[184:187], v[88:91]
v_mfma_f32_16x16x32_bf16 v[92:95], v[128:131], v[188:191], v[92:95]
v_mfma_f32_16x16x32_bf16 v[96:99], v[132:135], v[188:191], v[96:99]
v_mfma_f32_16x16x32_bf16 v[100:103], v[136:139], v[188:191], v[100:103]
v_mfma_f32_16x16x32_bf16 v[104:107], v[128:131], v[192:195], v[104:107]
v_mfma_f32_16x16x32_bf16 v[108:111], v[132:135], v[192:195], v[108:111]
v_mfma_f32_16x16x32_bf16 v[112:115], v[136:139], v[192:195], v[112:115]
s_lshl_b32 s59, s4, 4
s_add_u32 s59, s59, s5
s_mul_i32 s59, s59, 45056
s_mul_i32 s64, s7, 11264
s_add_u32 s59, s59, s64
v_add_u32 v31, s59, v29
s_mov_b32 s28, s54
s_mov_b32 s29, s55
s_mov_b32 s30, 11534336
s_mov_b32 s31, 0x20000
v_cvt_pk_bf16_f32 v214, v32, v33
v_cvt_pk_bf16_f32 v215, v34, v35
v_cvt_pk_bf16_f32 v216, v36, v37
v_cvt_pk_bf16_f32 v217, v38, v39
v_cvt_pk_bf16_f32 v218, v40, v41
v_cvt_pk_bf16_f32 v219, v42, v43
v_cvt_pk_bf16_f32 v220, v44, v45
v_cvt_pk_bf16_f32 v221, v46, v47
v_cvt_pk_bf16_f32 v222, v48, v49
v_cvt_pk_bf16_f32 v223, v50, v51
v_cvt_pk_bf16_f32 v224, v52, v53
v_cvt_pk_bf16_f32 v225, v54, v55
v_cvt_pk_bf16_f32 v226, v56, v57
v_cvt_pk_bf16_f32 v227, v58, v59
v_cvt_pk_bf16_f32 v228, v60, v61
v_cvt_pk_bf16_f32 v229, v62, v63
v_cvt_pk_bf16_f32 v230, v64, v65
v_cvt_pk_bf16_f32 v231, v66, v67
v_cvt_pk_bf16_f32 v232, v68, v69
v_cvt_pk_bf16_f32 v233, v70, v71
v_cvt_pk_bf16_f32 v234, v72, v73
v_cvt_pk_bf16_f32 v235, v74, v75
v_cvt_pk_bf16_f32 v236, v76, v77
v_cvt_pk_bf16_f32 v237, v78, v79
v_cvt_pk_bf16_f32 v238, v80, v81
v_cvt_pk_bf16_f32 v239, v82, v83
v_cvt_pk_bf16_f32 v240, v84, v85
v_cvt_pk_bf16_f32 v241, v86, v87
v_cvt_pk_bf16_f32 v242, v88, v89
v_cvt_pk_bf16_f32 v243, v90, v91
v_cvt_pk_bf16_f32 v244, v92, v93
v_cvt_pk_bf16_f32 v245, v94, v95
v_cvt_pk_bf16_f32 v246, v96, v97
v_cvt_pk_bf16_f32 v247, v98, v99
v_cvt_pk_bf16_f32 v248, v100, v101
v_cvt_pk_bf16_f32 v249, v102, v103
v_cvt_pk_bf16_f32 v250, v104, v105
v_cvt_pk_bf16_f32 v251, v106, v107
v_cvt_pk_bf16_f32 v252, v108, v109
v_cvt_pk_bf16_f32 v253, v110, v111
v_cvt_pk_bf16_f32 v254, v112, v113
v_cvt_pk_bf16_f32 v255, v114, v115
s_waitcnt lgkmcnt(0)
v_mfma_f32_16x16x32_bf16 v[32:35], v[214:217], v[196:199], 0
v_mfma_f32_16x16x32_bf16 v[36:39], v[214:217], v[202:205], 0
v_mfma_f32_16x16x32_bf16 v[40:43], v[214:217], v[208:211], 0
v_mfma_f32_16x16x32_bf16 v[44:47], v[220:223], v[196:199], 0
v_mfma_f32_16x16x32_bf16 v[48:51], v[220:223], v[202:205], 0
v_mfma_f32_16x16x32_bf16 v[52:55], v[220:223], v[208:211], 0
v_mfma_f32_16x16x16_bf16 v[32:35], v[218:219], v[200:201], v[32:35]
v_mfma_f32_16x16x16_bf16 v[36:39], v[218:219], v[206:207], v[36:39]
v_mfma_f32_16x16x16_bf16 v[40:43], v[218:219], v[212:213], v[40:43]
v_mfma_f32_16x16x32_bf16 v[56:59], v[226:229], v[196:199], 0
v_mfma_f32_16x16x32_bf16 v[60:63], v[226:229], v[202:205], 0
v_mfma_f32_16x16x32_bf16 v[64:67], v[226:229], v[208:211], 0
v_mfma_f32_16x16x16_bf16 v[44:47], v[224:225], v[200:201], v[44:47]
v_mfma_f32_16x16x16_bf16 v[48:51], v[224:225], v[206:207], v[48:51]
v_mfma_f32_16x16x16_bf16 v[52:55], v[224:225], v[212:213], v[52:55]
v_mfma_f32_16x16x32_bf16 v[68:71], v[232:235], v[196:199], 0
v_mfma_f32_16x16x32_bf16 v[72:75], v[232:235], v[202:205], 0
v_mfma_f32_16x16x32_bf16 v[76:79], v[232:235], v[208:211], 0
v_mfma_f32_16x16x16_bf16 v[56:59], v[230:231], v[200:201], v[56:59]
v_mfma_f32_16x16x16_bf16 v[60:63], v[230:231], v[206:207], v[60:63]
v_mfma_f32_16x16x16_bf16 v[64:67], v[230:231], v[212:213], v[64:67]
v_cvt_pk_bf16_f32 v120, v32, v33
v_cvt_pk_bf16_f32 v121, v34, v35
v_cvt_pk_bf16_f32 v122, v36, v37
v_cvt_pk_bf16_f32 v123, v38, v39
buffer_store_dwordx4 v[120:123], v31, s[28:31], 0 offen offset:0 sc1
v_cvt_pk_bf16_f32 v124, v40, v41
v_cvt_pk_bf16_f32 v125, v42, v43
v_mfma_f32_16x16x32_bf16 v[80:83], v[238:241], v[196:199], 0
v_mfma_f32_16x16x32_bf16 v[84:87], v[238:241], v[202:205], 0
v_mfma_f32_16x16x32_bf16 v[88:91], v[238:241], v[208:211], 0
v_mfma_f32_16x16x16_bf16 v[68:71], v[236:237], v[200:201], v[68:71]
v_mfma_f32_16x16x16_bf16 v[72:75], v[236:237], v[206:207], v[72:75]
v_mfma_f32_16x16x16_bf16 v[76:79], v[236:237], v[212:213], v[76:79]
v_cvt_pk_bf16_f32 v126, v44, v45
v_cvt_pk_bf16_f32 v127, v46, v47
buffer_store_dwordx4 v[124:127], v31, s[28:31], 0 offen offset:1024 sc1
v_cvt_pk_bf16_f32 v128, v48, v49
v_cvt_pk_bf16_f32 v129, v50, v51
v_cvt_pk_bf16_f32 v130, v52, v53
v_cvt_pk_bf16_f32 v131, v54, v55
buffer_store_dwordx4 v[128:131], v31, s[28:31], 0 offen offset:2048 sc1
v_mfma_f32_16x16x32_bf16 v[92:95], v[244:247], v[196:199], 0
v_mfma_f32_16x16x32_bf16 v[96:99], v[244:247], v[202:205], 0
v_mfma_f32_16x16x32_bf16 v[100:103], v[244:247], v[208:211], 0
v_mfma_f32_16x16x16_bf16 v[80:83], v[242:243], v[200:201], v[80:83]
v_mfma_f32_16x16x16_bf16 v[84:87], v[242:243], v[206:207], v[84:87]
v_mfma_f32_16x16x16_bf16 v[88:91], v[242:243], v[212:213], v[88:91]
v_cvt_pk_bf16_f32 v132, v56, v57
v_cvt_pk_bf16_f32 v133, v58, v59
v_cvt_pk_bf16_f32 v134, v60, v61
v_cvt_pk_bf16_f32 v135, v62, v63
buffer_store_dwordx4 v[132:135], v31, s[28:31], 0 offen offset:3072 sc1
v_cvt_pk_bf16_f32 v136, v64, v65
v_cvt_pk_bf16_f32 v137, v66, v67
v_mfma_f32_16x16x32_bf16 v[104:107], v[250:253], v[196:199], 0
v_mfma_f32_16x16x32_bf16 v[108:111], v[250:253], v[202:205], 0
v_mfma_f32_16x16x32_bf16 v[112:115], v[250:253], v[208:211], 0
v_mfma_f32_16x16x16_bf16 v[92:95], v[248:249], v[200:201], v[92:95]
v_mfma_f32_16x16x16_bf16 v[96:99], v[248:249], v[206:207], v[96:99]
v_mfma_f32_16x16x16_bf16 v[100:103], v[248:249], v[212:213], v[100:103]
v_cvt_pk_bf16_f32 v138, v68, v69
v_cvt_pk_bf16_f32 v139, v70, v71
v_add_u32 v31, 4096, v31
buffer_store_dwordx4 v[136:139], v31, s[28:31], 0 offen offset:0 sc1
v_cvt_pk_bf16_f32 v140, v72, v73
v_cvt_pk_bf16_f32 v141, v74, v75
v_cvt_pk_bf16_f32 v142, v76, v77
v_cvt_pk_bf16_f32 v143, v78, v79
buffer_store_dwordx4 v[140:143], v31, s[28:31], 0 offen offset:1024 sc1
v_mfma_f32_16x16x16_bf16 v[104:107], v[254:255], v[200:201], v[104:107]
v_mfma_f32_16x16x16_bf16 v[108:111], v[254:255], v[206:207], v[108:111]
v_mfma_f32_16x16x16_bf16 v[112:115], v[254:255], v[212:213], v[112:115]
v_cvt_pk_bf16_f32 v144, v80, v81
v_cvt_pk_bf16_f32 v145, v82, v83
v_cvt_pk_bf16_f32 v146, v84, v85
v_cvt_pk_bf16_f32 v147, v86, v87
buffer_store_dwordx4 v[144:147], v31, s[28:31], 0 offen offset:2048 sc1
v_cvt_pk_bf16_f32 v148, v88, v89
v_cvt_pk_bf16_f32 v149, v90, v91
s_nop 7
v_cvt_pk_bf16_f32 v150, v92, v93
v_cvt_pk_bf16_f32 v151, v94, v95
buffer_store_dwordx4 v[148:151], v31, s[28:31], 0 offen offset:3072 sc1
v_cvt_pk_bf16_f32 v152, v96, v97
v_cvt_pk_bf16_f32 v153, v98, v99
v_cvt_pk_bf16_f32 v154, v100, v101
v_cvt_pk_bf16_f32 v155, v102, v103
v_add_u32 v31, 4096, v31
buffer_store_dwordx4 v[152:155], v31, s[28:31], 0 offen offset:0 sc1
s_nop 7
v_cvt_pk_bf16_f32 v156, v104, v105
v_cvt_pk_bf16_f32 v157, v106, v107
v_cvt_pk_bf16_f32 v158, v108, v109
v_cvt_pk_bf16_f32 v159, v110, v111
buffer_store_dwordx4 v[156:159], v31, s[28:31], 0 offen offset:1024 sc1
v_cvt_pk_bf16_f32 v160, v112, v113
v_cvt_pk_bf16_f32 v161, v114, v115
buffer_store_dwordx2 v[160:161], v31, s[28:31], 0 offen offset:2048 sc1
s_endpgm
L_loader:
s_setprio 3
s_mov_b32 s16, s40
s_mov_b32 s17, s41
s_mov_b32 s18, 688128
s_mov_b32 s19, 0x20000
v_lshrrev_b32 v8, 3, v2
v_and_b32 v6, 7, v2
v_xor_b32 v6, v6, v4
v_lshlrev_b32 v9, 4, v6
v_mul_u32_u24 v5, 896, v8
v_add_u32 v5, v5, v9
s_mul_i32 s57, s4, 43008
v_add_u32 v5, s57, v5
v_xor_b32 v21, 64, v5
v_add_u32 v21, 7168, v21
s_and_b32 s64, s7, 1
s_cmp_eq_u32 s64, 0
s_cselect_b64 vcc, -1, 0
v_cndmask_b32 v20, v21, v5, vcc
v_lshl_add_u32 v22, v8, 9, v9
v_add_u32 v22, s56, v22
v_xor_b32 v23, 64, v22
v_add_u32 v26, 4096, v23
v_cndmask_b32 v25, v26, v22, vcc
s_lshl_b32 s57, s7, 7
v_add_u32 v22, s57, v22
v_add_u32 v23, s57, v23
s_mov_b32 s8, s46
s_mov_b32 s9, s47
s_mov_b32 s10, 3670016
s_mov_b32 s11, 0x20000
v_and_b32 v9, 7, v2
v_and_b32 v10, 1, v4
v_lshlrev_b32 v10, 1, v10
v_xor_b32 v9, v9, v10
v_lshlrev_b32 v9, 4, v9
v_lshl_add_u32 v6, v8, 13, v9
s_lshl_b32 s57, s5, 9
s_lshl_b32 s64, s7, 7
s_add_u32 s57, s57, s64
v_add_u32 v6, s57, v6
v_xor_b32 v7, 64, v6
s_mul_i32 s60, s62, 524288
s_add_u32 s64, s7, 0
s_lshr_b32 s67, s64, 1
s_mul_i32 s65, s67, 43691
s_lshr_b32 s65, s65, 17
s_mul_i32 s66, s65, 3
s_sub_u32 s66, s67, s66
s_mul_i32 s66, s66, 14336
s_lshl_b32 s65, s65, 7
s_add_u32 s65, s65, s66
s_lshl_b32 s66, s64, 10
s_mov_b32 m0, s66
s_nop 0
buffer_load_dwordx4 v20, s[16:19], s65 offen lds
s_add_u32 s64, s7, 4
s_lshr_b32 s67, s64, 1
s_mul_i32 s65, s67, 43691
s_lshr_b32 s65, s65, 17
s_mul_i32 s66, s65, 3
s_sub_u32 s66, s67, s66
s_mul_i32 s66, s66, 14336
s_lshl_b32 s65, s65, 7
s_add_u32 s65, s65, s66
s_lshl_b32 s66, s64, 10
s_mov_b32 m0, s66
s_nop 0
buffer_load_dwordx4 v20, s[16:19], s65 offen lds
s_add_u32 s64, s7, 8
s_lshr_b32 s67, s64, 1
s_mul_i32 s65, s67, 43691
s_lshr_b32 s65, s65, 17
s_mul_i32 s66, s65, 3
s_sub_u32 s66, s67, s66
s_mul_i32 s66, s66, 14336
s_lshl_b32 s65, s65, 7
s_add_u32 s65, s65, s66
s_lshl_b32 s66, s64, 10
s_mov_b32 m0, s66
s_nop 0
buffer_load_dwordx4 v20, s[16:19], s65 offen lds
s_add_u32 s64, s7, 12
s_lshr_b32 s67, s64, 1
s_mul_i32 s65, s67, 43691
s_lshr_b32 s65, s65, 17
s_mul_i32 s66, s65, 3
s_sub_u32 s66, s67, s66
s_mul_i32 s66, s66, 14336
s_lshl_b32 s65, s65, 7
s_add_u32 s65, s65, s66
s_lshl_b32 s66, s64, 10
s_mov_b32 m0, s66
s_nop 0
buffer_load_dwordx4 v20, s[16:19], s65 offen lds
s_add_u32 s64, s7, 16
s_lshr_b32 s67, s64, 1
s_mul_i32 s65, s67, 43691
s_lshr_b32 s65, s65, 17
s_mul_i32 s66, s65, 3
s_sub_u32 s66, s67, s66
s_mul_i32 s66, s66, 14336
s_lshl_b32 s65, s65, 7
s_add_u32 s65, s65, s66
s_lshl_b32 s66, s64, 10
s_mov_b32 m0, s66
s_nop 0
buffer_load_dwordx4 v20, s[16:19], s65 offen lds
s_add_u32 s64, s7, 20
s_lshr_b32 s67, s64, 1
s_mul_i32 s65, s67, 43691
s_lshr_b32 s65, s65, 17
s_mul_i32 s66, s65, 3
s_sub_u32 s66, s67, s66
s_mul_i32 s66, s66, 14336
s_lshl_b32 s65, s65, 7
s_add_u32 s65, s65, s66
s_lshl_b32 s66, s64, 10
s_mov_b32 m0, s66
s_nop 0
buffer_load_dwordx4 v20, s[16:19], s65 offen lds
s_add_u32 s64, s7, 24
s_lshr_b32 s67, s64, 1
s_mul_i32 s65, s67, 43691
s_lshr_b32 s65, s65, 17
s_mul_i32 s66, s65, 3
s_sub_u32 s66, s67, s66
s_mul_i32 s66, s66, 14336
s_lshl_b32 s65, s65, 7
s_add_u32 s65, s65, s66
s_lshl_b32 s66, s64, 10
s_mov_b32 m0, s66
s_nop 0
buffer_load_dwordx4 v20, s[16:19], s65 offen lds
s_add_u32 s64, s7, 28
s_lshr_b32 s67, s64, 1
s_mul_i32 s65, s67, 43691
s_lshr_b32 s65, s65, 17
s_mul_i32 s66, s65, 3
s_sub_u32 s66, s67, s66
s_mul_i32 s66, s66, 14336
s_lshl_b32 s65, s65, 7
s_add_u32 s65, s65, s66
s_lshl_b32 s66, s64, 10
s_mov_b32 m0, s66
s_nop 0
buffer_load_dwordx4 v20, s[16:19], s65 offen lds
s_add_u32 s64, s7, 32
s_lshr_b32 s67, s64, 1
s_mul_i32 s65, s67, 43691
s_lshr_b32 s65, s65, 17
s_mul_i32 s66, s65, 3
s_sub_u32 s66, s67, s66
s_mul_i32 s66, s66, 14336
s_lshl_b32 s65, s65, 7
s_add_u32 s65, s65, s66
s_lshl_b32 s66, s64, 10
s_mov_b32 m0, s66
s_nop 0
buffer_load_dwordx4 v20, s[16:19], s65 offen lds
s_add_u32 s64, s7, 36
s_lshr_b32 s67, s64, 1
s_mul_i32 s65, s67, 43691
s_lshr_b32 s65, s65, 17
s_mul_i32 s66, s65, 3
s_sub_u32 s66, s67, s66
s_mul_i32 s66, s66, 14336
s_lshl_b32 s65, s65, 7
s_add_u32 s65, s65, s66
s_lshl_b32 s66, s64, 10
s_mov_b32 m0, s66
s_nop 0
buffer_load_dwordx4 v20, s[16:19], s65 offen lds
s_add_u32 s64, s7, 40
s_cmp_ge_u32 s64, 42
s_cbranch_scc1 L_xdone
s_lshr_b32 s67, s64, 1
s_mul_i32 s65, s67, 43691
s_lshr_b32 s65, s65, 17
s_mul_i32 s66, s65, 3
s_sub_u32 s66, s67, s66
s_mul_i32 s66, s66, 14336
s_lshl_b32 s65, s65, 7
s_add_u32 s65, s65, s66
s_lshl_b32 s66, s64, 10
s_mov_b32 m0, s66
s_nop 0
buffer_load_dwordx4 v20, s[16:19], s65 offen lds
L_xdone:
s_add_u32 m0, s58, 0
s_add_u32 s59, s60, 0
buffer_load_dwordx4 v6, s[8:11], s59 offen lds
s_add_u32 m0, s58, 1024
s_add_u32 s59, s60, 65536
buffer_load_dwordx4 v7, s[8:11], s59 offen lds
s_add_u32 m0, s58, 2048
s_add_u32 s59, s60, 131072
buffer_load_dwordx4 v6, s[8:11], s59 offen lds
s_add_u32 m0, s58, 3072
s_add_u32 s59, s60, 196608
buffer_load_dwordx4 v7, s[8:11], s59 offen lds
s_add_u32 s60, s60, 262144
s_cmp_eq_u32 s60, 3670016
s_cselect_b32 s60, 0, s60
s_add_u32 m0, s58, 4096
s_add_u32 s59, s60, 0
buffer_load_dwordx4 v6, s[8:11], s59 offen lds
s_add_u32 m0, s58, 5120
s_add_u32 s59, s60, 65536
buffer_load_dwordx4 v7, s[8:11], s59 offen lds
s_add_u32 m0, s58, 6144
s_add_u32 s59, s60, 131072
buffer_load_dwordx4 v6, s[8:11], s59 offen lds
s_add_u32 m0, s58, 7168
s_add_u32 s59, s60, 196608
buffer_load_dwordx4 v7, s[8:11], s59 offen lds
s_add_u32 s60, s60, 262144
s_cmp_eq_u32 s60, 3670016
s_cselect_b32 s60, 0, s60
s_waitcnt vmcnt(4)
s_barrier
s_add_u32 m0, s58, 8192
s_add_u32 s59, s60, 0
buffer_load_dwordx4 v6, s[8:11], s59 offen lds
s_add_u32 m0, s58, 9216
s_add_u32 s59, s60, 65536
buffer_load_dwordx4 v7, s[8:11], s59 offen lds
s_add_u32 m0, s58, 10240
s_add_u32 s59, s60, 131072
buffer_load_dwordx4 v6, s[8:11], s59 offen lds
s_add_u32 m0, s58, 11264
s_add_u32 s59, s60, 196608
buffer_load_dwordx4 v7, s[8:11], s59 offen lds
s_add_u32 s60, s60, 262144
s_cmp_eq_u32 s60, 3670016
s_cselect_b32 s60, 0, s60
s_add_u32 m0, s58, 12288
s_add_u32 s59, s60, 0
buffer_load_dwordx4 v6, s[8:11], s59 offen lds
s_add_u32 m0, s58, 13312
s_add_u32 s59, s60, 65536
buffer_load_dwordx4 v7, s[8:11], s59 offen lds
s_add_u32 m0, s58, 14336
s_add_u32 s59, s60, 131072
buffer_load_dwordx4 v6, s[8:11], s59 offen lds
s_add_u32 m0, s58, 15360
s_add_u32 s59, s60, 196608
buffer_load_dwordx4 v7, s[8:11], s59 offen lds
s_add_u32 s60, s60, 262144
s_cmp_eq_u32 s60, 3670016
s_cselect_b32 s60, 0, s60
s_mov_b32 s24, s44
s_mov_b32 s25, s45
s_mov_b32 s26, 3145728
s_mov_b32 s27, 0x20000
s_mov_b32 s20, s42
s_mov_b32 s21, s43
s_mov_b32 s22, 3145728
s_mov_b32 s23, 0x20000
s_mov_b32 s12, s48
s_mov_b32 s13, s49
s_mov_b32 s14, 3670016
s_mov_b32 s15, 0x20000
s_mul_i32 s57, s5, 229376
s_mul_i32 s64, s7, 224
s_add_u32 s57, s57, s64
v_add_u32 v17, 0, v2
v_mul_u32_u24 v18, 74899, v17
v_lshrrev_b32 v18, 20, v18
v_mul_u32_u24 v19, 14, v18
v_sub_u32 v19, v17, v19
v_and_b32 v27, 4, v18
v_and_b32 v28, 8, v18
v_and_b32 v18, 0x13, v18
v_lshl_or_b32 v18, v27, 1, v18
v_lshrrev_b32 v28, 1, v28
v_or_b32 v18, v18, v28
v_mul_u32_u24 v18, 896, v18
v_lshlrev_b32 v19, 4, v19
v_add_u32 v18, v18, v19
v_add_u32 v10, s57, v18
v_add_u32 v17, 64, v2
v_mul_u32_u24 v18, 74899, v17
v_lshrrev_b32 v18, 20, v18
v_mul_u32_u24 v19, 14, v18
v_sub_u32 v19, v17, v19
v_and_b32 v27, 4, v18
v_and_b32 v28, 8, v18
v_and_b32 v18, 0x13, v18
v_lshl_or_b32 v18, v27, 1, v18
v_lshrrev_b32 v28, 1, v28
v_or_b32 v18, v18, v28
v_mul_u32_u24 v18, 896, v18
v_lshlrev_b32 v19, 4, v19
v_add_u32 v18, v18, v19
v_add_u32 v11, s57, v18
v_add_u32 v17, 128, v2
v_mul_u32_u24 v18, 74899, v17
v_lshrrev_b32 v18, 20, v18
v_mul_u32_u24 v19, 14, v18
v_sub_u32 v19, v17, v19
v_and_b32 v27, 4, v18
v_and_b32 v28, 8, v18
v_and_b32 v18, 0x13, v18
v_lshl_or_b32 v18, v27, 1, v18
v_lshrrev_b32 v28, 1, v28
v_or_b32 v18, v18, v28
v_mul_u32_u24 v18, 896, v18
v_lshlrev_b32 v19, 4, v19
v_add_u32 v18, v18, v19
v_add_u32 v12, s57, v18
v_add_u32 v17, 192, v2
v_mul_u32_u24 v18, 74899, v17
v_lshrrev_b32 v18, 20, v18
v_mul_u32_u24 v19, 14, v18
v_sub_u32 v19, v17, v19
v_and_b32 v27, 4, v18
v_and_b32 v28, 8, v18
v_and_b32 v18, 0x13, v18
v_lshl_or_b32 v18, v27, 1, v18
v_lshrrev_b32 v28, 1, v28
v_or_b32 v18, v18, v28
v_mul_u32_u24 v18, 896, v18
v_lshlrev_b32 v19, 4, v19
v_add_u32 v18, v18, v19
v_add_u32 v13, s57, v18
v_add_u32 v17, 256, v2
v_mul_u32_u24 v18, 74899, v17
v_lshrrev_b32 v18, 20, v18
v_mul_u32_u24 v19, 14, v18
v_sub_u32 v19, v17, v19
v_and_b32 v27, 4, v18
v_and_b32 v28, 8, v18
v_and_b32 v18, 0x13, v18
v_lshl_or_b32 v18, v27, 1, v18
v_lshrrev_b32 v28, 1, v28
v_or_b32 v18, v18, v28
v_mul_u32_u24 v18, 896, v18
v_lshlrev_b32 v19, 4, v19
v_add_u32 v18, v18, v19
v_add_u32 v14, s57, v18
v_add_u32 v17, 320, v2
v_mul_u32_u24 v18, 74899, v17
v_lshrrev_b32 v18, 20, v18
v_mul_u32_u24 v19, 14, v18
v_sub_u32 v19, v17, v19
v_and_b32 v27, 4, v18
v_and_b32 v28, 8, v18
v_and_b32 v18, 0x13, v18
v_lshl_or_b32 v18, v27, 1, v18
v_lshrrev_b32 v28, 1, v28
v_or_b32 v18, v18, v28
v_mul_u32_u24 v18, 896, v18
v_lshlrev_b32 v19, 4, v19
v_add_u32 v18, v18, v19
v_add_u32 v15, s57, v18
v_add_u32 v17, 384, v2
v_mul_u32_u24 v18, 74899, v17
v_lshrrev_b32 v18, 20, v18
v_mul_u32_u24 v19, 14, v18
v_sub_u32 v19, v17, v19
v_and_b32 v27, 4, v18
v_and_b32 v28, 8, v18
v_and_b32 v18, 0x13, v18
v_lshl_or_b32 v18, v27, 1, v18
v_lshrrev_b32 v28, 1, v28
v_or_b32 v18, v18, v28
v_mul_u32_u24 v18, 896, v18
v_lshlrev_b32 v19, 4, v19
v_add_u32 v18, v18, v19
v_add_u32 v16, s57, v18
s_mul_i32 s61, s63, 57344
s_waitcnt vmcnt(8)
s_barrier
s_add_u32 m0, s58, 16384
s_add_u32 s59, s60, 0
buffer_load_dwordx4 v6, s[8:11], s59 offen lds
s_add_u32 m0, s58, 17408
s_add_u32 s59, s60, 65536
buffer_load_dwordx4 v7, s[8:11], s59 offen lds
s_add_u32 m0, s58, 18432
s_add_u32 s59, s60, 131072
buffer_load_dwordx4 v6, s[8:11], s59 offen lds
s_add_u32 m0, s58, 19456
s_add_u32 s59, s60, 196608
buffer_load_dwordx4 v7, s[8:11], s59 offen lds
s_add_u32 s60, s60, 262144
s_cmp_eq_u32 s60, 3670016
s_cselect_b32 s60, 0, s60
s_waitcnt vmcnt(8)
s_barrier
s_add_u32 m0, s58, 0
s_add_u32 s59, s60, 0
buffer_load_dwordx4 v6, s[8:11], s59 offen lds
s_add_u32 m0, s58, 1024
s_add_u32 s59, s60, 65536
buffer_load_dwordx4 v7, s[8:11], s59 offen lds
s_add_u32 m0, s58, 2048
s_add_u32 s59, s60, 131072
buffer_load_dwordx4 v6, s[8:11], s59 offen lds
s_add_u32 m0, s58, 3072
s_add_u32 s59, s60, 196608
buffer_load_dwordx4 v7, s[8:11], s59 offen lds
s_add_u32 s60, s60, 262144
s_cmp_eq_u32 s60, 3670016
s_cselect_b32 s60, 0, s60
s_waitcnt vmcnt(8)
s_barrier
s_add_u32 m0, s58, 4096
s_add_u32 s59, s60, 0
buffer_load_dwordx4 v6, s[8:11], s59 offen lds
s_add_u32 m0, s58, 5120
s_add_u32 s59, s60, 65536
buffer_load_dwordx4 v7, s[8:11], s59 offen lds
s_add_u32 m0, s58, 6144
s_add_u32 s59, s60, 131072
buffer_load_dwordx4 v6, s[8:11], s59 offen lds
s_add_u32 m0, s58, 7168
s_add_u32 s59, s60, 196608
buffer_load_dwordx4 v7, s[8:11], s59 offen lds
s_add_u32 s60, s60, 262144
s_cmp_eq_u32 s60, 3670016
s_cselect_b32 s60, 0, s60
s_add_u32 m0, s58, 8192
s_add_u32 s59, s60, 0
buffer_load_dwordx4 v6, s[8:11], s59 offen lds
s_add_u32 m0, s58, 9216
s_add_u32 s59, s60, 65536
buffer_load_dwordx4 v7, s[8:11], s59 offen lds
s_add_u32 m0, s58, 10240
s_add_u32 s59, s60, 131072
buffer_load_dwordx4 v6, s[8:11], s59 offen lds
s_add_u32 m0, s58, 11264
s_add_u32 s59, s60, 196608
buffer_load_dwordx4 v7, s[8:11], s59 offen lds
s_add_u32 s60, s60, 262144
s_cmp_eq_u32 s60, 3670016
s_cselect_b32 s60, 0, s60
s_waitcnt vmcnt(12)
s_barrier
s_add_u32 m0, s58, 12288
s_add_u32 s59, s60, 0
buffer_load_dwordx4 v6, s[8:11], s59 offen lds
s_add_u32 m0, s58, 13312
s_add_u32 s59, s60, 65536
buffer_load_dwordx4 v7, s[8:11], s59 offen lds
s_add_u32 m0, s58, 14336
s_add_u32 s59, s60, 131072
buffer_load_dwordx4 v6, s[8:11], s59 offen lds
s_add_u32 m0, s58, 15360
s_add_u32 s59, s60, 196608
buffer_load_dwordx4 v7, s[8:11], s59 offen lds
s_add_u32 s60, s60, 262144
s_cmp_eq_u32 s60, 3670016
s_cselect_b32 s60, 0, s60
s_waitcnt vmcnt(12)
s_barrier
s_add_u32 m0, s58, 16384
s_add_u32 s59, s60, 0
buffer_load_dwordx4 v6, s[8:11], s59 offen lds
s_add_u32 m0, s58, 17408
s_add_u32 s59, s60, 65536
buffer_load_dwordx4 v7, s[8:11], s59 offen lds
s_add_u32 m0, s58, 18432
s_add_u32 s59, s60, 131072
buffer_load_dwordx4 v6, s[8:11], s59 offen lds
s_add_u32 m0, s58, 19456
s_add_u32 s59, s60, 196608
buffer_load_dwordx4 v7, s[8:11], s59 offen lds
s_add_u32 s60, s60, 262144
s_cmp_eq_u32 s60, 3670016
s_cselect_b32 s60, 0, s60
s_waitcnt vmcnt(12)
s_barrier
s_add_u32 m0, s58, 0
s_add_u32 s59, s60, 0
buffer_load_dwordx4 v6, s[8:11], s59 offen lds
s_add_u32 m0, s58, 1024
s_add_u32 s59, s60, 65536
buffer_load_dwordx4 v7, s[8:11], s59 offen lds
s_add_u32 m0, s58, 2048
s_add_u32 s59, s60, 131072
buffer_load_dwordx4 v6, s[8:11], s59 offen lds
s_add_u32 m0, s58, 3072
s_add_u32 s59, s60, 196608
buffer_load_dwordx4 v7, s[8:11], s59 offen lds
s_add_u32 s60, s60, 262144
s_cmp_eq_u32 s60, 3670016
s_cselect_b32 s60, 0, s60
s_waitcnt vmcnt(12)
s_barrier
s_add_u32 m0, s58, 4096
s_add_u32 s59, s60, 0
buffer_load_dwordx4 v6, s[8:11], s59 offen lds
s_add_u32 m0, s58, 5120
s_add_u32 s59, s60, 65536
buffer_load_dwordx4 v7, s[8:11], s59 offen lds
s_add_u32 m0, s58, 6144
s_add_u32 s59, s60, 131072
buffer_load_dwordx4 v6, s[8:11], s59 offen lds
s_add_u32 m0, s58, 7168
s_add_u32 s59, s60, 196608
buffer_load_dwordx4 v7, s[8:11], s59 offen lds
s_add_u32 s60, s60, 262144
s_cmp_eq_u32 s60, 3670016
s_cselect_b32 s60, 0, s60
s_waitcnt vmcnt(12)
s_barrier
s_add_u32 m0, s58, 8192
s_add_u32 s59, s60, 0
buffer_load_dwordx4 v6, s[8:11], s59 offen lds
s_add_u32 m0, s58, 9216
s_add_u32 s59, s60, 65536
buffer_load_dwordx4 v7, s[8:11], s59 offen lds
s_add_u32 m0, s58, 10240
s_add_u32 s59, s60, 131072
buffer_load_dwordx4 v6, s[8:11], s59 offen lds
s_add_u32 m0, s58, 11264
s_add_u32 s59, s60, 196608
buffer_load_dwordx4 v7, s[8:11], s59 offen lds
s_add_u32 s60, s60, 262144
s_cmp_eq_u32 s60, 3670016
s_cselect_b32 s60, 0, s60
s_waitcnt vmcnt(12)
s_barrier
s_add_u32 m0, s58, 12288
s_add_u32 s59, s60, 0
buffer_load_dwordx4 v6, s[8:11], s59 offen lds
s_add_u32 m0, s58, 13312
s_add_u32 s59, s60, 65536
buffer_load_dwordx4 v7, s[8:11], s59 offen lds
s_add_u32 m0, s58, 14336
s_add_u32 s59, s60, 131072
buffer_load_dwordx4 v6, s[8:11], s59 offen lds
s_add_u32 m0, s58, 15360
s_add_u32 s59, s60, 196608
buffer_load_dwordx4 v7, s[8:11], s59 offen lds
s_add_u32 s60, s60, 262144
s_cmp_eq_u32 s60, 3670016
s_cselect_b32 s60, 0, s60
s_add_u32 s64, s7, 0
s_lshr_b32 s67, s64, 1
s_mul_i32 s65, s67, 43691
s_lshr_b32 s65, s65, 17
s_mul_i32 s66, s65, 3
s_sub_u32 s66, s67, s66
s_lshl_b32 s66, s66, 13
s_lshl_b32 s65, s65, 7
s_add_u32 s65, s65, s66
s_lshl_b32 s66, s64, 10
s_add_u32 m0, s66, 43008
s_nop 0
buffer_load_dwordx4 v25, s[24:27], s65 offen lds
s_add_u32 s64, s7, 4
s_lshr_b32 s67, s64, 1
s_mul_i32 s65, s67, 43691
s_lshr_b32 s65, s65, 17
s_mul_i32 s66, s65, 3
s_sub_u32 s66, s67, s66
s_lshl_b32 s66, s66, 13
s_lshl_b32 s65, s65, 7
s_add_u32 s65, s65, s66
s_lshl_b32 s66, s64, 10
s_add_u32 m0, s66, 43008
s_nop 0
buffer_load_dwordx4 v25, s[24:27], s65 offen lds
s_add_u32 s64, s7, 8
s_lshr_b32 s67, s64, 1
s_mul_i32 s65, s67, 43691
s_lshr_b32 s65, s65, 17
s_mul_i32 s66, s65, 3
s_sub_u32 s66, s67, s66
s_lshl_b32 s66, s66, 13
s_lshl_b32 s65, s65, 7
s_add_u32 s65, s65, s66
s_lshl_b32 s66, s64, 10
s_add_u32 m0, s66, 43008
s_nop 0
buffer_load_dwordx4 v25, s[24:27], s65 offen lds
s_add_u32 s64, s7, 12
s_lshr_b32 s67, s64, 1
s_mul_i32 s65, s67, 43691
s_lshr_b32 s65, s65, 17
s_mul_i32 s66, s65, 3
s_sub_u32 s66, s67, s66
s_lshl_b32 s66, s66, 13
s_lshl_b32 s65, s65, 7
s_add_u32 s65, s65, s66
s_lshl_b32 s66, s64, 10
s_add_u32 m0, s66, 43008
s_nop 0
buffer_load_dwordx4 v25, s[24:27], s65 offen lds
s_add_u32 s64, s7, 16
s_lshr_b32 s67, s64, 1
s_mul_i32 s65, s67, 43691
s_lshr_b32 s65, s65, 17
s_mul_i32 s66, s65, 3
s_sub_u32 s66, s67, s66
s_lshl_b32 s66, s66, 13
s_lshl_b32 s65, s65, 7
s_add_u32 s65, s65, s66
s_lshl_b32 s66, s64, 10
s_add_u32 m0, s66, 43008
s_nop 0
buffer_load_dwordx4 v25, s[24:27], s65 offen lds
s_add_u32 s64, s7, 20
s_lshr_b32 s67, s64, 1
s_mul_i32 s65, s67, 43691
s_lshr_b32 s65, s65, 17
s_mul_i32 s66, s65, 3
s_sub_u32 s66, s67, s66
s_lshl_b32 s66, s66, 13
s_lshl_b32 s65, s65, 7
s_add_u32 s65, s65, s66
s_lshl_b32 s66, s64, 10
s_add_u32 m0, s66, 43008
s_nop 0
buffer_load_dwordx4 v25, s[24:27], s65 offen lds
s_waitcnt vmcnt(18)
s_barrier
s_add_u32 m0, s58, 16384
s_mov_b32 s59, 0
buffer_load_dwordx4 v22, s[20:23], s59 offen lds
s_add_u32 m0, s58, 17408
s_mov_b32 s59, 4096
buffer_load_dwordx4 v23, s[20:23], s59 offen lds
s_add_u32 m0, s58, 18432
s_mov_b32 s59, 8192
buffer_load_dwordx4 v22, s[20:23], s59 offen lds
s_add_u32 m0, s58, 19456
s_mov_b32 s59, 12288
buffer_load_dwordx4 v23, s[20:23], s59 offen lds
s_add_u32 m0, s58, 20480
s_mov_b32 s59, 16384
buffer_load_dwordx4 v22, s[20:23], s59 offen lds
s_add_u32 m0, s58, 21504
s_mov_b32 s59, 20480
buffer_load_dwordx4 v23, s[20:23], s59 offen lds
s_waitcnt vmcnt(20)
s_barrier
s_waitcnt vmcnt(16)
s_barrier
s_add_u32 m0, s58, 0
s_nop 0
buffer_load_dwordx4 v10, s[12:15], s61 offen lds
s_add_u32 m0, s58, 1024
s_nop 0
buffer_load_dwordx4 v11, s[12:15], s61 offen lds
s_add_u32 m0, s58, 2048
s_nop 0
buffer_load_dwordx4 v12, s[12:15], s61 offen lds
s_add_u32 m0, s58, 3072
s_nop 0
buffer_load_dwordx4 v13, s[12:15], s61 offen lds
s_add_u32 m0, s58, 4096
s_nop 0
buffer_load_dwordx4 v14, s[12:15], s61 offen lds
s_add_u32 m0, s58, 5120
s_nop 0
buffer_load_dwordx4 v15, s[12:15], s61 offen lds
s_add_u32 m0, s58, 6144
s_nop 0
buffer_load_dwordx4 v16, s[12:15], s61 offen lds
s_add_u32 s61, s61, 28672
s_cmp_eq_u32 s61, 229376
s_cselect_b32 s61, 0, s61
s_waitcnt vmcnt(19)
s_barrier
s_waitcnt vmcnt(7)
s_barrier
s_add_u32 m0, s58, 7168
s_nop 0
buffer_load_dwordx4 v10, s[12:15], s61 offen lds
s_add_u32 m0, s58, 8192
s_nop 0
buffer_load_dwordx4 v11, s[12:15], s61 offen lds
s_add_u32 m0, s58, 9216
s_nop 0
buffer_load_dwordx4 v12, s[12:15], s61 offen lds
s_add_u32 m0, s58, 10240
s_nop 0
buffer_load_dwordx4 v13, s[12:15], s61 offen lds
s_add_u32 m0, s58, 11264
s_nop 0
buffer_load_dwordx4 v14, s[12:15], s61 offen lds
s_add_u32 m0, s58, 12288
s_nop 0
buffer_load_dwordx4 v15, s[12:15], s61 offen lds
s_add_u32 m0, s58, 13312
s_nop 0
buffer_load_dwordx4 v16, s[12:15], s61 offen lds
s_add_u32 s61, s61, 28672
s_cmp_eq_u32 s61, 229376
s_cselect_b32 s61, 0, s61
s_barrier
s_add_u32 m0, s58, 14336
s_nop 0
buffer_load_dwordx4 v10, s[12:15], s61 offen lds
s_add_u32 m0, s58, 15360
s_nop 0
buffer_load_dwordx4 v11, s[12:15], s61 offen lds
s_add_u32 m0, s58, 16384
s_nop 0
buffer_load_dwordx4 v12, s[12:15], s61 offen lds
s_add_u32 m0, s58, 17408
s_nop 0
buffer_load_dwordx4 v13, s[12:15], s61 offen lds
s_add_u32 m0, s58, 18432
s_nop 0
buffer_load_dwordx4 v14, s[12:15], s61 offen lds
s_add_u32 m0, s58, 19456
s_nop 0
buffer_load_dwordx4 v15, s[12:15], s61 offen lds
s_add_u32 m0, s58, 20480
s_nop 0
buffer_load_dwordx4 v16, s[12:15], s61 offen lds
s_add_u32 s61, s61, 28672
s_cmp_eq_u32 s61, 229376
s_cselect_b32 s61, 0, s61
s_waitcnt vmcnt(14)
s_barrier
s_waitcnt vmcnt(7)
s_barrier
s_add_u32 m0, s58, 0
s_nop 0
buffer_load_dwordx4 v10, s[12:15], s61 offen lds
s_add_u32 m0, s58, 1024
s_nop 0
buffer_load_dwordx4 v11, s[12:15], s61 offen lds
s_add_u32 m0, s58, 2048
s_nop 0
buffer_load_dwordx4 v12, s[12:15], s61 offen lds
s_add_u32 m0, s58, 3072
s_nop 0
buffer_load_dwordx4 v13, s[12:15], s61 offen lds
s_add_u32 m0, s58, 4096
s_nop 0
buffer_load_dwordx4 v14, s[12:15], s61 offen lds
s_add_u32 m0, s58, 5120
s_nop 0
buffer_load_dwordx4 v15, s[12:15], s61 offen lds
s_add_u32 m0, s58, 6144
s_nop 0
buffer_load_dwordx4 v16, s[12:15], s61 offen lds
s_add_u32 s61, s61, 28672
s_cmp_eq_u32 s61, 229376
s_cselect_b32 s61, 0, s61
s_waitcnt vmcnt(7)
s_barrier
s_add_u32 m0, s58, 7168
s_nop 0
buffer_load_dwordx4 v10, s[12:15], s61 offen lds
s_add_u32 m0, s58, 8192
s_nop 0
buffer_load_dwordx4 v11, s[12:15], s61 offen lds
s_add_u32 m0, s58, 9216
s_nop 0
buffer_load_dwordx4 v12, s[12:15], s61 offen lds
s_add_u32 m0, s58, 10240
s_nop 0
buffer_load_dwordx4 v13, s[12:15], s61 offen lds
s_add_u32 m0, s58, 11264
s_nop 0
buffer_load_dwordx4 v14, s[12:15], s61 offen lds
s_add_u32 m0, s58, 12288
s_nop 0
buffer_load_dwordx4 v15, s[12:15], s61 offen lds
s_add_u32 m0, s58, 13312
s_nop 0
buffer_load_dwordx4 v16, s[12:15], s61 offen lds
s_add_u32 s61, s61, 28672
s_cmp_eq_u32 s61, 229376
s_cselect_b32 s61, 0, s61
s_waitcnt vmcnt(7)
s_barrier
s_add_u32 m0, s58, 14336
s_nop 0
buffer_load_dwordx4 v10, s[12:15], s61 offen lds
s_add_u32 m0, s58, 15360
s_nop 0
buffer_load_dwordx4 v11, s[12:15], s61 offen lds
s_add_u32 m0, s58, 16384
s_nop 0
buffer_load_dwordx4 v12, s[12:15], s61 offen lds
s_add_u32 m0, s58, 17408
s_nop 0
buffer_load_dwordx4 v13, s[12:15], s61 offen lds
s_add_u32 m0, s58, 18432
s_nop 0
buffer_load_dwordx4 v14, s[12:15], s61 offen lds
s_add_u32 m0, s58, 19456
s_nop 0
buffer_load_dwordx4 v15, s[12:15], s61 offen lds
s_add_u32 m0, s58, 20480
s_nop 0
buffer_load_dwordx4 v16, s[12:15], s61 offen lds
s_add_u32 s61, s61, 28672
s_cmp_eq_u32 s61, 229376
s_cselect_b32 s61, 0, s61
s_waitcnt vmcnt(7)
s_barrier
s_add_u32 m0, s58, 0
s_nop 0
buffer_load_dwordx4 v10, s[12:15], s61 offen lds
s_add_u32 m0, s58, 1024
s_nop 0
buffer_load_dwordx4 v11, s[12:15], s61 offen lds
s_add_u32 m0, s58, 2048
s_nop 0
buffer_load_dwordx4 v12, s[12:15], s61 offen lds
s_add_u32 m0, s58, 3072
s_nop 0
buffer_load_dwordx4 v13, s[12:15], s61 offen lds
s_add_u32 m0, s58, 4096
s_nop 0
buffer_load_dwordx4 v14, s[12:15], s61 offen lds
s_add_u32 m0, s58, 5120
s_nop 0
buffer_load_dwordx4 v15, s[12:15], s61 offen lds
s_add_u32 m0, s58, 6144
s_nop 0
buffer_load_dwordx4 v16, s[12:15], s61 offen lds
s_add_u32 s61, s61, 28672
s_cmp_eq_u32 s61, 229376
s_cselect_b32 s61, 0, s61
s_waitcnt vmcnt(7)
s_barrier
s_add_u32 m0, s58, 7168
s_nop 0
buffer_load_dwordx4 v10, s[12:15], s61 offen lds
s_add_u32 m0, s58, 8192
s_nop 0
buffer_load_dwordx4 v11, s[12:15], s61 offen lds
s_add_u32 m0, s58, 9216
s_nop 0
buffer_load_dwordx4 v12, s[12:15], s61 offen lds
s_add_u32 m0, s58, 10240
s_nop 0
buffer_load_dwordx4 v13, s[12:15], s61 offen lds
s_add_u32 m0, s58, 11264
s_nop 0
buffer_load_dwordx4 v14, s[12:15], s61 offen lds
s_add_u32 m0, s58, 12288
s_nop 0
buffer_load_dwordx4 v15, s[12:15], s61 offen lds
s_add_u32 m0, s58, 13312
s_nop 0
buffer_load_dwordx4 v16, s[12:15], s61 offen lds
s_add_u32 s61, s61, 28672
s_cmp_eq_u32 s61, 229376
s_cselect_b32 s61, 0, s61
s_waitcnt vmcnt(7)
s_barrier
s_waitcnt vmcnt(0)
s_barrier
L_end:
s_endpgm
.text
.globl gqa_reduce_kernel
.p2align 8
.type gqa_reduce_kernel,@function
gqa_reduce_kernel:
s_cmp_ge_u32 s2, 256
s_cbranch_scc1 L_end2
s_load_dwordx8 s[40:47], s[0:1], 0
s_load_dwordx8 s[48:55], s[0:1], 32
s_and_b32 s3, s2, 7
s_lshr_b32 s4, s2, 3
s_and_b32 s4, s4, 15
s_lshr_b32 s5, s2, 7
s_lshl_b32 s6, s3, 1
s_add_u32 s5, s5, s6
s_waitcnt lgkmcnt(0)
s_mov_b32 s28, s54
s_mov_b32 s29, s55
s_mov_b32 s30, 11534336
s_mov_b32 s31, 0x20000
s_mov_b32 s32, s50
s_mov_b32 s33, s51
s_mov_b32 s34, 688128
s_mov_b32 s35, 0x20000
s_mul_i32 s64, s4, 720896
s_mul_i32 s59, s5, 176
v_add_u32 v32, s59, v0
v_cmp_gt_u32 vcc, 176, v0
s_and_saveexec_b64 s[66:67], vcc
s_cbranch_execz L_rdone
v_lshlrev_b32 v36, 4, v32
v_add_u32 v36, s64, v36
s_mov_b32 s65, 0
buffer_load_dwordx4 v[40:43], v36, s[28:31], s65 offen
s_add_u32 s65, s65, 45056
buffer_load_dwordx4 v[44:47], v36, s[28:31], s65 offen
s_add_u32 s65, s65, 45056
buffer_load_dwordx4 v[48:51], v36, s[28:31], s65 offen
s_add_u32 s65, s65, 45056
buffer_load_dwordx4 v[52:55], v36, s[28:31], s65 offen
s_add_u32 s65, s65, 45056
buffer_load_dwordx4 v[56:59], v36, s[28:31], s65 offen
s_add_u32 s65, s65, 45056
buffer_load_dwordx4 v[60:63], v36, s[28:31], s65 offen
s_add_u32 s65, s65, 45056
buffer_load_dwordx4 v[64:67], v36, s[28:31], s65 offen
s_add_u32 s65, s65, 45056
buffer_load_dwordx4 v[68:71], v36, s[28:31], s65 offen
s_add_u32 s65, s65, 45056
buffer_load_dwordx4 v[72:75], v36, s[28:31], s65 offen
s_add_u32 s65, s65, 45056
buffer_load_dwordx4 v[76:79], v36, s[28:31], s65 offen
s_add_u32 s65, s65, 45056
buffer_load_dwordx4 v[80:83], v36, s[28:31], s65 offen
s_add_u32 s65, s65, 45056
buffer_load_dwordx4 v[84:87], v36, s[28:31], s65 offen
s_add_u32 s65, s65, 45056
buffer_load_dwordx4 v[88:91], v36, s[28:31], s65 offen
s_add_u32 s65, s65, 45056
buffer_load_dwordx4 v[92:95], v36, s[28:31], s65 offen
s_add_u32 s65, s65, 45056
buffer_load_dwordx4 v[96:99], v36, s[28:31], s65 offen
s_add_u32 s65, s65, 45056
buffer_load_dwordx4 v[100:103], v36, s[28:31], s65 offen
s_add_u32 s65, s65, 45056
v_lshrrev_b32 v33, 6, v32
v_mul_u32_u24 v34, 5958, v33
v_lshrrev_b32 v34, 16, v34
v_mul_u32_u24 v35, 11, v34
v_sub_u32 v35, v33, v35
v_lshlrev_b32 v35, 1, v35
v_mul_u32_u24 v37, 21, v34
v_add_u32 v37, v37, v35
v_mul_u32_u24 v105, 43691, v37
v_lshrrev_b32 v105, 17, v105
v_mul_u32_u24 v104, 3, v105
v_sub_u32 v104, v37, v104
v_and_b32 v39, 15, v32
v_lshl_add_u32 v104, v104, 4, v39
v_bfe_u32 v39, v32, 4, 2
v_lshlrev_b32 v39, 2, v39
v_lshl_add_u32 v105, v105, 4, v39
s_mul_i32 s65, s4, 48
v_add_u32 v104, s65, v104
v_mul_u32_u24 v104, 448, v104
v_add_lshl_u32 v104, v104, v105, 1
v_add_u32 v38, 1, v37
v_mul_u32_u24 v107, 43691, v38
v_lshrrev_b32 v107, 17, v107
v_mul_u32_u24 v106, 3, v107
v_sub_u32 v106, v38, v106
v_and_b32 v39, 15, v32
v_lshl_add_u32 v106, v106, 4, v39
v_bfe_u32 v39, v32, 4, 2
v_lshlrev_b32 v39, 2, v39
v_lshl_add_u32 v107, v107, 4, v39
s_mul_i32 s65, s4, 48
v_add_u32 v106, s65, v106
v_mul_u32_u24 v106, 448, v106
v_add_lshl_u32 v106, v106, v107, 1
s_waitcnt vmcnt(0)
v_lshlrev_b32 v110, 16, v40
v_and_b32 v111, 0xffff0000, v40
v_lshlrev_b32 v112, 16, v41
v_and_b32 v113, 0xffff0000, v41
v_lshlrev_b32 v114, 16, v42
v_and_b32 v115, 0xffff0000, v42
v_lshlrev_b32 v116, 16, v43
v_and_b32 v117, 0xffff0000, v43
v_lshlrev_b32 v118, 16, v44
v_and_b32 v119, 0xffff0000, v44
v_add_f32 v110, v110, v118
v_add_f32 v111, v111, v119
v_lshlrev_b32 v118, 16, v45
v_and_b32 v119, 0xffff0000, v45
v_add_f32 v112, v112, v118
v_add_f32 v113, v113, v119
v_lshlrev_b32 v118, 16, v46
v_and_b32 v119, 0xffff0000, v46
v_add_f32 v114, v114, v118
v_add_f32 v115, v115, v119
v_lshlrev_b32 v118, 16, v47
v_and_b32 v119, 0xffff0000, v47
v_add_f32 v116, v116, v118
v_add_f32 v117, v117, v119
v_lshlrev_b32 v118, 16, v48
v_and_b32 v119, 0xffff0000, v48
v_add_f32 v110, v110, v118
v_add_f32 v111, v111, v119
v_lshlrev_b32 v118, 16, v49
v_and_b32 v119, 0xffff0000, v49
v_add_f32 v112, v112, v118
v_add_f32 v113, v113, v119
v_lshlrev_b32 v118, 16, v50
v_and_b32 v119, 0xffff0000, v50
v_add_f32 v114, v114, v118
v_add_f32 v115, v115, v119
v_lshlrev_b32 v118, 16, v51
v_and_b32 v119, 0xffff0000, v51
v_add_f32 v116, v116, v118
v_add_f32 v117, v117, v119
v_lshlrev_b32 v118, 16, v52
v_and_b32 v119, 0xffff0000, v52
v_add_f32 v110, v110, v118
v_add_f32 v111, v111, v119
v_lshlrev_b32 v118, 16, v53
v_and_b32 v119, 0xffff0000, v53
v_add_f32 v112, v112, v118
v_add_f32 v113, v113, v119
v_lshlrev_b32 v118, 16, v54
v_and_b32 v119, 0xffff0000, v54
v_add_f32 v114, v114, v118
v_add_f32 v115, v115, v119
v_lshlrev_b32 v118, 16, v55
v_and_b32 v119, 0xffff0000, v55
v_add_f32 v116, v116, v118
v_add_f32 v117, v117, v119
v_lshlrev_b32 v118, 16, v56
v_and_b32 v119, 0xffff0000, v56
v_add_f32 v110, v110, v118
v_add_f32 v111, v111, v119
v_lshlrev_b32 v118, 16, v57
v_and_b32 v119, 0xffff0000, v57
v_add_f32 v112, v112, v118
v_add_f32 v113, v113, v119
v_lshlrev_b32 v118, 16, v58
v_and_b32 v119, 0xffff0000, v58
v_add_f32 v114, v114, v118
v_add_f32 v115, v115, v119
v_lshlrev_b32 v118, 16, v59
v_and_b32 v119, 0xffff0000, v59
v_add_f32 v116, v116, v118
v_add_f32 v117, v117, v119
v_lshlrev_b32 v118, 16, v60
v_and_b32 v119, 0xffff0000, v60
v_add_f32 v110, v110, v118
v_add_f32 v111, v111, v119
v_lshlrev_b32 v118, 16, v61
v_and_b32 v119, 0xffff0000, v61
v_add_f32 v112, v112, v118
v_add_f32 v113, v113, v119
v_lshlrev_b32 v118, 16, v62
v_and_b32 v119, 0xffff0000, v62
v_add_f32 v114, v114, v118
v_add_f32 v115, v115, v119
v_lshlrev_b32 v118, 16, v63
v_and_b32 v119, 0xffff0000, v63
v_add_f32 v116, v116, v118
v_add_f32 v117, v117, v119
v_lshlrev_b32 v118, 16, v64
v_and_b32 v119, 0xffff0000, v64
v_add_f32 v110, v110, v118
v_add_f32 v111, v111, v119
v_lshlrev_b32 v118, 16, v65
v_and_b32 v119, 0xffff0000, v65
v_add_f32 v112, v112, v118
v_add_f32 v113, v113, v119
v_lshlrev_b32 v118, 16, v66
v_and_b32 v119, 0xffff0000, v66
v_add_f32 v114, v114, v118
v_add_f32 v115, v115, v119
v_lshlrev_b32 v118, 16, v67
v_and_b32 v119, 0xffff0000, v67
v_add_f32 v116, v116, v118
v_add_f32 v117, v117, v119
v_lshlrev_b32 v118, 16, v68
v_and_b32 v119, 0xffff0000, v68
v_add_f32 v110, v110, v118
v_add_f32 v111, v111, v119
v_lshlrev_b32 v118, 16, v69
v_and_b32 v119, 0xffff0000, v69
v_add_f32 v112, v112, v118
v_add_f32 v113, v113, v119
v_lshlrev_b32 v118, 16, v70
v_and_b32 v119, 0xffff0000, v70
v_add_f32 v114, v114, v118
v_add_f32 v115, v115, v119
v_lshlrev_b32 v118, 16, v71
v_and_b32 v119, 0xffff0000, v71
v_add_f32 v116, v116, v118
v_add_f32 v117, v117, v119
v_lshlrev_b32 v118, 16, v72
v_and_b32 v119, 0xffff0000, v72
v_add_f32 v110, v110, v118
v_add_f32 v111, v111, v119
v_lshlrev_b32 v118, 16, v73
v_and_b32 v119, 0xffff0000, v73
v_add_f32 v112, v112, v118
v_add_f32 v113, v113, v119
v_lshlrev_b32 v118, 16, v74
v_and_b32 v119, 0xffff0000, v74
v_add_f32 v114, v114, v118
v_add_f32 v115, v115, v119
v_lshlrev_b32 v118, 16, v75
v_and_b32 v119, 0xffff0000, v75
v_add_f32 v116, v116, v118
v_add_f32 v117, v117, v119
v_lshlrev_b32 v118, 16, v76
v_and_b32 v119, 0xffff0000, v76
v_add_f32 v110, v110, v118
v_add_f32 v111, v111, v119
v_lshlrev_b32 v118, 16, v77
v_and_b32 v119, 0xffff0000, v77
v_add_f32 v112, v112, v118
v_add_f32 v113, v113, v119
v_lshlrev_b32 v118, 16, v78
v_and_b32 v119, 0xffff0000, v78
v_add_f32 v114, v114, v118
v_add_f32 v115, v115, v119
v_lshlrev_b32 v118, 16, v79
v_and_b32 v119, 0xffff0000, v79
v_add_f32 v116, v116, v118
v_add_f32 v117, v117, v119
v_lshlrev_b32 v118, 16, v80
v_and_b32 v119, 0xffff0000, v80
v_add_f32 v110, v110, v118
v_add_f32 v111, v111, v119
v_lshlrev_b32 v118, 16, v81
v_and_b32 v119, 0xffff0000, v81
v_add_f32 v112, v112, v118
v_add_f32 v113, v113, v119
v_lshlrev_b32 v118, 16, v82
v_and_b32 v119, 0xffff0000, v82
v_add_f32 v114, v114, v118
v_add_f32 v115, v115, v119
v_lshlrev_b32 v118, 16, v83
v_and_b32 v119, 0xffff0000, v83
v_add_f32 v116, v116, v118
v_add_f32 v117, v117, v119
v_lshlrev_b32 v118, 16, v84
v_and_b32 v119, 0xffff0000, v84
v_add_f32 v110, v110, v118
v_add_f32 v111, v111, v119
v_lshlrev_b32 v118, 16, v85
v_and_b32 v119, 0xffff0000, v85
v_add_f32 v112, v112, v118
v_add_f32 v113, v113, v119
v_lshlrev_b32 v118, 16, v86
v_and_b32 v119, 0xffff0000, v86
v_add_f32 v114, v114, v118
v_add_f32 v115, v115, v119
v_lshlrev_b32 v118, 16, v87
v_and_b32 v119, 0xffff0000, v87
v_add_f32 v116, v116, v118
v_add_f32 v117, v117, v119
v_lshlrev_b32 v118, 16, v88
v_and_b32 v119, 0xffff0000, v88
v_add_f32 v110, v110, v118
v_add_f32 v111, v111, v119
v_lshlrev_b32 v118, 16, v89
v_and_b32 v119, 0xffff0000, v89
v_add_f32 v112, v112, v118
v_add_f32 v113, v113, v119
v_lshlrev_b32 v118, 16, v90
v_and_b32 v119, 0xffff0000, v90
v_add_f32 v114, v114, v118
v_add_f32 v115, v115, v119
v_lshlrev_b32 v118, 16, v91
v_and_b32 v119, 0xffff0000, v91
v_add_f32 v116, v116, v118
v_add_f32 v117, v117, v119
v_lshlrev_b32 v118, 16, v92
v_and_b32 v119, 0xffff0000, v92
v_add_f32 v110, v110, v118
v_add_f32 v111, v111, v119
v_lshlrev_b32 v118, 16, v93
v_and_b32 v119, 0xffff0000, v93
v_add_f32 v112, v112, v118
v_add_f32 v113, v113, v119
v_lshlrev_b32 v118, 16, v94
v_and_b32 v119, 0xffff0000, v94
v_add_f32 v114, v114, v118
v_add_f32 v115, v115, v119
v_lshlrev_b32 v118, 16, v95
v_and_b32 v119, 0xffff0000, v95
v_add_f32 v116, v116, v118
v_add_f32 v117, v117, v119
v_lshlrev_b32 v118, 16, v96
v_and_b32 v119, 0xffff0000, v96
v_add_f32 v110, v110, v118
v_add_f32 v111, v111, v119
v_lshlrev_b32 v118, 16, v97
v_and_b32 v119, 0xffff0000, v97
v_add_f32 v112, v112, v118
v_add_f32 v113, v113, v119
v_lshlrev_b32 v118, 16, v98
v_and_b32 v119, 0xffff0000, v98
v_add_f32 v114, v114, v118
v_add_f32 v115, v115, v119
v_lshlrev_b32 v118, 16, v99
v_and_b32 v119, 0xffff0000, v99
v_add_f32 v116, v116, v118
v_add_f32 v117, v117, v119
v_lshlrev_b32 v118, 16, v100
v_and_b32 v119, 0xffff0000, v100
v_add_f32 v110, v110, v118
v_add_f32 v111, v111, v119
v_lshlrev_b32 v118, 16, v101
v_and_b32 v119, 0xffff0000, v101
v_add_f32 v112, v112, v118
v_add_f32 v113, v113, v119
v_lshlrev_b32 v118, 16, v102
v_and_b32 v119, 0xffff0000, v102
v_add_f32 v114, v114, v118
v_add_f32 v115, v115, v119
v_lshlrev_b32 v118, 16, v103
v_and_b32 v119, 0xffff0000, v103
v_add_f32 v116, v116, v118
v_add_f32 v117, v117, v119
v_cvt_pk_bf16_f32 v120, v110, v111
v_cvt_pk_bf16_f32 v121, v112, v113
v_cvt_pk_bf16_f32 v122, v114, v115
v_cvt_pk_bf16_f32 v123, v116, v117
buffer_store_dwordx2 v[120:121], v104, s[32:35], 0 offen
v_cmp_gt_u32 vcc, 20, v35
s_and_b64 exec, exec, vcc
s_cbranch_execz L_rdone
buffer_store_dwordx2 v[122:123], v106, s[32:35], 0 offen
L_rdone:
s_mov_b64 exec, s[66:67]
L_end2:
s_endpgm
.section .rodata,"a"
.p2align 6
.amdhsa_kernel standalone__gqa_block_cached__near_ridge_kernel
  .amdhsa_next_free_vgpr 256
  .amdhsa_next_free_sgpr 96
  .amdhsa_accum_offset 256
  .amdhsa_group_segment_fixed_size 0
  .amdhsa_kernarg_size 64
  .amdhsa_user_sgpr_count 2
  .amdhsa_user_sgpr_kernarg_segment_ptr 1
  .amdhsa_system_sgpr_workgroup_id_x 1
.end_amdhsa_kernel
.section .rodata,"a"
.p2align 6
.amdhsa_kernel gqa_reduce_kernel
  .amdhsa_next_free_vgpr 128
  .amdhsa_next_free_sgpr 96
  .amdhsa_accum_offset 128
  .amdhsa_group_segment_fixed_size 0
  .amdhsa_kernarg_size 64
  .amdhsa_user_sgpr_count 2
  .amdhsa_user_sgpr_kernarg_segment_ptr 1
  .amdhsa_system_sgpr_workgroup_id_x 1
.end_amdhsa_kernel
```
